```python
import torch

def _softmax(x, axis=-1):
    return torch.softmax(x, dim=axis)
def _gelu(x):
    return torch.nn.functional.gelu(x, approximate="tanh")
def _silu(x):
    return torch.nn.functional.silu(x)
def _sigmoid(x):
    return torch.sigmoid(x)
def _layernorm(x, axis=-1, eps=1e-5):
    m = x.mean(dim=axis, keepdim=True)
    v = x.var(dim=axis, keepdim=True, unbiased=False)
    return (x - m) / torch.sqrt(v + eps)
def _scatter_add(tgt, idx, src, axis=0):
    return tgt.clone().index_add_(axis, idx, src)
def _segment_sum(src, seg, n):
    out = torch.zeros((n,) + src.shape[1:], dtype=src.dtype)
    return out.index_add_(0, seg, src)
def _pad(x, pw):
    flat = tuple(v for pair in reversed(pw) for v in pair)
    return torch.nn.functional.pad(x, flat)

kernel_name = 'sequential_preLN__mha_block__dense_activation_squared_relu__prompt'

def setup_inputs():

    _w = (lambda a: (lambda t: t.to(torch.bfloat16) if t.is_floating_point() else t)(torch.as_tensor(a)))
    def _A_setup():
        B, S, D, H = 1, 2048, 448, 16
        return {
            "x": _w((lambda *s: torch.randn(*s, dtype=torch.bfloat16) * 0.05)(B, S, D)),
            "wqkv": _w((lambda *s: torch.randn(*s, dtype=torch.bfloat16) * 0.05)(D, 3 * D)),
            "wo": _w((lambda *s: torch.randn(*s, dtype=torch.bfloat16) * 0.05)(D, D)),
        }
    _A_in = _A_setup()

    def _B_setup():
        B, S, D, F = 1, 2048, 448, 1792
        return {
            "x": _w((lambda *s: torch.randn(*s, dtype=torch.bfloat16) * 0.05)(B, S, D)),
            "w1": _w((lambda *s: torch.randn(*s, dtype=torch.bfloat16) * 0.05)(D, F)),
            "b1": _w((lambda *s: torch.randn(*s, dtype=torch.bfloat16) * 0.2)(F)),
            "w2": _w((lambda *s: torch.randn(*s, dtype=torch.bfloat16) * 0.05)(F, D)),
            "b2": _w((lambda *s: torch.randn(*s, dtype=torch.bfloat16) * 0.8)(D)),
        }
    _B_in = _B_setup()

    return {
        "A_x": _A_in["x"],
        "A_wqkv": _A_in["wqkv"],
        "A_wo": _A_in["wo"],
        "B_x": _B_in["x"],
        "B_w1": _B_in["w1"],
        "B_b1": _B_in["b1"],
        "B_w2": _B_in["w2"],
        "B_b2": _B_in["b2"],
    }

def reference(A_x, A_wqkv, A_wo, B_x, B_w1, B_b1, B_w2, B_b2):
    def _A_ref(x, wqkv, wo):
        B, S, D = x.shape
        H = 16
        Dh = D // H
        qkv = (lambda x, *d: x.permute(*d))((x @ wqkv).reshape(B, S, 3, H, Dh), 2, 0, 3, 1, 4)
        q, k, v = qkv[0], qkv[1], qkv[2]
        scores = torch.einsum("bhqd,bhkd->bhqk", q, k) * (Dh ** -0.5)
        p = _softmax(scores, axis=-1)
        o = torch.einsum("bhqk,bhkd->bhqd", p, v)
        return (lambda x, *d: x.permute(*d))(o, 0, 2, 1, 3).reshape(B, S, D) @ wo

    def _B_ref(x, w1, b1, w2, b2):
        h = torch.einsum("bsd,df->bsf", x, w1) + b1
        zero = torch.zeros_like(h)
        r = torch.where(h > zero, h, zero)
        h = r * r
        out = torch.einsum("bsf,fd->bsd", h, w2) + b2
        return out

    x = A_x
    h = x + _A_ref(_layernorm(x, axis=-1), A_wqkv, A_wo)
    h2 = h + _B_ref(_layernorm(h, axis=-1), B_w1, B_b1, B_w2, B_b2)
    return h2
```

```asm
; @launch grid=(256,1,1) block=(512,1,1) lds=163840
.amdgcn_target "amdgcn-amd-amdhsa--gfx950"
.text
.globl sequential_preLN__mha_block__dense_activation_squared_relu__prompt_kernel
.p2align 12
.p2align 8
.type sequential_preLN__mha_block__dense_activation_squared_relu__prompt_kernel,@function
sequential_preLN__mha_block__dense_activation_squared_relu__prompt_kernel:
    s_cmp_ge_u32 s2, 256
    s_cbranch_scc1 Lend
    s_load_dwordx4 s[36:39], s[0:1], 0
    s_load_dwordx2 s[12:13], s[0:1], 80
    v_lshrrev_b32 v3, 6, v0
    v_and_b32 v0, 63, v0
    v_readfirstlane_b32 s3, v3
    s_and_b32 s4, s2, 7
    s_lshr_b32 s5, s2, 3
    s_and_b32 s68, s3, 3
    s_lshl_b32 s99, s4, 20
    s_add_u32 s99, s99, 6291456
    v_lshlrev_b32 v1, 4, v0
    v_cmp_eq_u32 vcc, 0, v0
    v_mov_b32 v3, 1073741824
    s_mov_b32 s14, 14680064
    s_mov_b32 s15, 0x20000
    v_cndmask_b32 v2, v3, 0, vcc
    s_cmp_lt_u32 s3, 4
    s_cbranch_scc1 LA_start
LB_start:
    s_setprio 3
    v_lshrrev_b32 v3, 4, v0
    v_and_b32 v4, 15, v0
    v_mul_u32_u24 v5, 2688, v3
    v_lshl_add_u32 v90, v4, 4, v5
    s_add_u32 s28, s68, 1
    s_cmp_eq_u32 s28, 3
    s_cselect_b32 s28, 0, s28
    s_mul_i32 s28, s28, 896
    s_mul_i32 s29, s4, 112
    s_and_b32 s30, s29, 127
    s_sub_u32 s29, s29, s30
    s_add_u32 s28, s28, s29
    s_mul_i32 s29, s5, 43008
    s_add_u32 s28, s28, s29
    s_mul_i32 s31, s68, 28672
    s_add_u32 s31, s31, 65536
    s_mov_b32 m0, s31
    s_mov_b32 s18, 1204224
    s_mov_b32 s19, 0x20000
    s_cmp_lt_u32 s5, 28
    s_cselect_b32 s32, s68, 3
    s_cmp_eq_u32 s32, 3
    s_waitcnt lgkmcnt(0)
    s_mov_b32 s16, s38
    s_mov_b32 s17, s39
    s_cbranch_scc1 LB_norep
    buffer_load_dwordx4 v90, s[16:19], s28 offen offset:0 lds
    s_add_u32 s28, s28, 9728
    buffer_load_dwordx4 v90, s[16:19], s28 offen offset:1024 lds
    s_add_u32 s28, s28, 9728
    buffer_load_dwordx4 v90, s[16:19], s28 offen offset:2048 lds
    s_add_u32 s28, s28, 9728
    buffer_load_dwordx4 v90, s[16:19], s28 offen offset:3072 lds
    buffer_load_dword v20, v2, s[12:15], 0 offen sc1
    s_mul_i32 s34, s68, 28
    s_add_u32 s34, s34, s5
    s_lshl_b32 s34, s34, 10
    s_add_u32 s34, s34, 524288
    s_add_u32 s34, s34, s99
    s_add_u32 s35, s34, 86016
    v_bfe_u32 v5, v0, 2, 3
    v_lshrrev_b32 v6, 5, v0
    v_mul_u32_u24 v6, 86016, v6
    v_lshl_add_u32 v5, v5, 7, v6
    buffer_load_dword v9, v5, s[12:15], s34 offen sc1
    s_and_b32 s28, s5, 1
    s_lshl1_add_u32 s6, s4, s28
    s_lshr_b32 s7, s5, 1
    s_mul_i32 s28, s28, 0
    s_mul_i32 s29, s4, 1
    s_add_u32 s28, s28, s29
    s_mul_i32 s29, s28, 37
    s_lshr_b32 s29, s29, 8
    s_mul_i32 s29, s29, 7
    s_sub_u32 s56, s28, s29
    s_add_u32 s57, s56, 1
    s_cmp_eq_u32 s57, 7
    s_cselect_b32 s57, 0, s57
    s_add_u32 s58, s57, 1
    s_cmp_eq_u32 s58, 7
    s_cselect_b32 s58, 0, s58
    s_add_u32 s59, s58, 1
    s_cmp_eq_u32 s59, 7
    s_cselect_b32 s59, 0, s59
    s_add_u32 s60, s59, 1
    s_cmp_eq_u32 s60, 7
    s_cselect_b32 s60, 0, s60
    s_add_u32 s61, s60, 1
    s_cmp_eq_u32 s61, 7
    s_cselect_b32 s61, 0, s61
    s_add_u32 s62, s61, 1
    s_cmp_eq_u32 s62, 7
    s_cselect_b32 s62, 0, s62
    s_load_dwordx8 s[40:47], s[0:1], 16
    s_load_dwordx4 s[48:51], s[0:1], 48
    s_load_dwordx2 s[52:53], s[0:1], 64
    s_mov_b32 s64, 0
    s_mov_b32 s65, -1
    s_mov_b32 s66, 0x88008800
    s_mov_b32 s67, 0x88008800
    s_mov_b32 s27, 0x20000
    s_mov_b32 s92, 0x3f803f80
    s_getreg_b32 s25, hwreg(HW_REG_XCC_ID, 0, 4)
    s_lshr_b32 s28, s5, 2
    s_lshl3_add_u32 s72, s4, s28
    s_and_b32 s28, s5, 3
    s_lshl2_add_u32 s73, s28, s68
    s_cmp_ge_u32 s5, 14
    s_cselect_b32 s28, 1, 0
    s_mul_i32 s29, s28, 14
    s_sub_u32 s75, s5, s29
    s_lshl1_add_u32 s28, s4, s28
    s_lshl2_add_u32 s74, s28, s68
    s_mul_i32 s28, s5, 37
    s_lshr_b32 s28, s28, 8
    s_mul_i32 s29, s28, 7
    s_sub_u32 s77, s5, s29
    s_lshl2_add_u32 s28, s4, s28
    s_lshl_b32 s76, s28, 1
    s_and_b32 s69, s6, 1
    s_lshl_b32 s69, s69, 18
    s_add_u32 s69, s69, s99
    s_waitcnt lgkmcnt(0)
    v_lshrrev_b32 v3, 5, v0
    v_bfe_u32 v4, v0, 2, 2
    v_lshl_add_u32 v4, v3, 3, v4
    v_lshlrev_b32 v4, 8, v4
    v_bfe_u32 v5, v0, 4, 1
    v_lshl_add_u32 v4, v5, 5, v4
    v_and_b32 v5, 3, v0
    v_lshl_add_u32 v4, v5, 3, v4
    s_add_u32 s30, s30, s31
    v_add_u32 v91, s30, v4
    v_and_b32 v5, 31, v0
    v_cmp_lt_u32 vcc, 10, v5
    s_nop 1
    v_addc_co_u32 v6, vcc, 0, v5, vcc
    v_cmp_lt_u32 vcc, 13, v5
    s_nop 1
    v_addc_co_u32 v6, vcc, 0, v6, vcc
    v_cmp_lt_u32 vcc, 24, v5
    s_nop 1
    v_addc_co_u32 v6, vcc, 0, v6, vcc
    s_cmp_eq_u32 s68, 1
    s_cselect_b64 vcc, -1, 0
    v_cndmask_b32 v6, v5, v6, vcc
    v_lshl_add_u32 v6, v3, 5, v6
    v_lshlrev_b32 v6, 4, v6
    s_cmp_eq_u32 s68, 0
    s_cselect_b32 s32, 0x80000000, 0
    s_mov_b32 s33, s32
    s_xor_b32 s28, s32, 0xf0000000
    s_mov_b32 s29, s28
    v_mov_b32 v7, 1073741824
    v_cndmask_b32 v19, v6, v7, s[28:29]
    v_bfe_u32 v10, v5, 2, 2
    v_add_u32 v8, 28, v10
    v_and_b32 v11, 1, v10
    v_lshlrev_b32 v11, 2, v11
    v_lshrrev_b32 v10, 1, v10
    v_lshl_add_u32 v11, v10, 4, v11
    v_add_u32 v11, 11, v11
    s_cmp_eq_u32 s68, 1
    s_cselect_b64 vcc, -1, 0
    v_cndmask_b32 v8, v8, v11, vcc
    v_bfe_u32 v10, v5, 4, 1
    v_lshl_add_u32 v8, v10, 5, v8
    v_lshrrev_b32 v10, 2, v5
    s_cmp_eq_u32 s68, 0
    s_cselect_b32 s82, 3, 99
    v_cmp_eq_u32 vcc, s82, v10
    v_mov_b32 v11, 1855
    v_and_b32 v10, 3, v5
    v_cndmask_b32 v8, v8, v11, vcc
    v_lshl_add_u32 v8, v8, 2, v10
    v_lshlrev_b32 v8, 2, v8
    v_mul_u32_u24 v3, 86016, v3
    v_add_u32 v8, v8, v3
    v_cmp_lt_u32 vcc, 27, v5
    v_mov_b32 v10, 0
    v_mov_b32 v11, 0
    v_cndmask_b32 v23, v8, v7, vcc
    v_mov_b32 v12, s92
    s_waitcnt vmcnt(1)
    ds_read_b64_tr_b16 v[32:33], v91 offset:0
    ds_read_b64_tr_b16 v[34:35], v91 offset:1024
    ds_read_b64_tr_b16 v[36:37], v91 offset:56
    ds_read_b64_tr_b16 v[38:39], v91 offset:1080
    s_waitcnt lgkmcnt(2)
    v_cndmask_b32 v32, v32, v12, s[32:33]
    v_cndmask_b32 v33, v33, v12, s[32:33]
    v_cndmask_b32 v34, v34, v12, s[32:33]
    v_cndmask_b32 v35, v35, v12, s[32:33]
    buffer_store_dwordx4 v[32:35], v19, s[12:15], s34 offen
    s_waitcnt lgkmcnt(0)
    v_cndmask_b32 v36, v36, v12, s[32:33]
    v_cndmask_b32 v37, v37, v12, s[32:33]
    v_cndmask_b32 v38, v38, v12, s[32:33]
    v_cndmask_b32 v39, v39, v12, s[32:33]
    buffer_store_dwordx4 v[36:39], v19, s[12:15], s35 offen
    v_dot2c_f32_bf16 v10, s92, v32
    v_dot2c_f32_bf16 v11, s92, v36
    v_dot2c_f32_bf16 v10, s92, v33
    v_dot2c_f32_bf16 v11, s92, v37
    v_dot2c_f32_bf16 v10, s92, v34
    v_dot2c_f32_bf16 v11, s92, v38
    v_dot2c_f32_bf16 v10, s92, v35
    v_dot2c_f32_bf16 v11, s92, v39
    s_nop 2
    v_permlane32_swap_b32 v10, v11
    v_add_f32 v10, v10, v11
    buffer_store_dword v10, v23, s[12:15], s34 offen
    s_branch LB_rep
LB_norep:
    buffer_load_dword v20, v2, s[12:15], 0 offen sc1
    s_getpc_b64 s[88:89]
Lpc:
    s_sub_u32 s88, s88, Lpc-sequential_preLN__mha_block__dense_activation_squared_relu__prompt_kernel
    s_subb_u32 s89, s89, 0
    s_mov_b32 s90, Lcode_end-sequential_preLN__mha_block__dense_activation_squared_relu__prompt_kernel
    s_mov_b32 s91, 0x20000
    s_lshl_b32 s28, s5, 11
    v_lshrrev_b32 v5, 2, v0
    v_lshlrev_b32 v5, 7, v5
    v_bfe_u32 v6, v0, 3, 2
    v_lshrrev_b32 v7, 5, v0
    v_lshlrev_b32 v6, 7, v6
    v_lshl_add_u32 v6, v7, 12, v6
    s_lshl_b32 s29, s4, 9
    s_add_u32 s29, s29, 4096
    buffer_load_dword v9, v6, s[12:15], s29 offen sc1
    buffer_load_dword v10, v5, s[88:91], s28 offen
    s_and_b32 s28, s5, 1
    s_lshl1_add_u32 s6, s4, s28
    s_lshr_b32 s7, s5, 1
    s_mul_i32 s28, s28, 0
    s_mul_i32 s29, s4, 1
    s_add_u32 s28, s28, s29
    s_mul_i32 s29, s28, 37
    s_lshr_b32 s29, s29, 8
    s_mul_i32 s29, s29, 7
    s_sub_u32 s56, s28, s29
    s_add_u32 s57, s56, 1
    s_cmp_eq_u32 s57, 7
    s_cselect_b32 s57, 0, s57
    s_add_u32 s58, s57, 1
    s_cmp_eq_u32 s58, 7
    s_cselect_b32 s58, 0, s58
    s_add_u32 s59, s58, 1
    s_cmp_eq_u32 s59, 7
    s_cselect_b32 s59, 0, s59
    s_add_u32 s60, s59, 1
    s_cmp_eq_u32 s60, 7
    s_cselect_b32 s60, 0, s60
    s_add_u32 s61, s60, 1
    s_cmp_eq_u32 s61, 7
    s_cselect_b32 s61, 0, s61
    s_add_u32 s62, s61, 1
    s_cmp_eq_u32 s62, 7
    s_cselect_b32 s62, 0, s62
    s_load_dwordx8 s[40:47], s[0:1], 16
    s_load_dwordx4 s[48:51], s[0:1], 48
    s_load_dwordx2 s[52:53], s[0:1], 64
    s_mov_b32 s64, 0
    s_mov_b32 s65, -1
    s_mov_b32 s66, 0x88008800
    s_mov_b32 s67, 0x88008800
    s_mov_b32 s27, 0x20000
    s_mov_b32 s92, 0x3f803f80
    s_getreg_b32 s25, hwreg(HW_REG_XCC_ID, 0, 4)
    s_lshr_b32 s28, s5, 2
    s_lshl3_add_u32 s72, s4, s28
    s_and_b32 s28, s5, 3
    s_lshl2_add_u32 s73, s28, s68
    s_cmp_ge_u32 s5, 14
    s_cselect_b32 s28, 1, 0
    s_mul_i32 s29, s28, 14
    s_sub_u32 s75, s5, s29
    s_lshl1_add_u32 s28, s4, s28
    s_lshl2_add_u32 s74, s28, s68
    s_mul_i32 s28, s5, 37
    s_lshr_b32 s28, s28, 8
    s_mul_i32 s29, s28, 7
    s_sub_u32 s77, s5, s29
    s_lshl2_add_u32 s28, s4, s28
    s_lshl_b32 s76, s28, 1
    s_and_b32 s69, s6, 1
    s_lshl_b32 s69, s69, 18
    s_add_u32 s69, s69, s99
    s_waitcnt lgkmcnt(0)
    s_waitcnt vmcnt(2)
LB_rep:
    s_barrier
    v_readfirstlane_b32 s82, v20
    s_add_u32 s25, s25, 1
    s_lshl_b32 s25, s25, 27
    s_mul_i32 s24, s82, 0x9E3779B1
    s_add_u32 s24, s24, 0x7F4A7C15
    s_xor_b32 s82, s82, s24
    s_and_b32 s82, s82, 0x9fff0000
    s_cselect_b32 s82, 0, 0x10000
    s_xor_b32 s24, s24, s82
    s_xor_b32 s25, s25, s24
    s_lshl_b32 s28, s4, 9
    s_add_u32 s28, s28, 4096
    s_lshl2_add_u32 s29, s5, s68
    s_lshl2_add_u32 s29, s29, s28
    v_mov_b32 v3, s25
    v_lshlrev_b32 v4, 3, v0
    s_mov_b32 s26, 0
    s_mov_b32 s30, 96
    s_waitcnt vmcnt(0)
    buffer_store_dword v3, v2, s[12:15], s29 offen
    s_mov_b32 s8, s36
    s_mov_b32 s9, s37
    s_mov_b32 s10, 1835008
    s_mov_b32 s11, 0x20000
    v_lshrrev_b32 v3, 3, v0
    v_and_b32 v4, 7, v0
    v_lshrrev_b32 v5, 1, v3
    v_xor_b32 v4, v4, v5
    v_mul_u32_u24 v3, 896, v3
    v_lshl_add_u32 v24, v4, 4, v3
    v_xor_b32 v25, 64, v24
    v_add_u32 v25, 6144, v25
    v_add_u32 v26, 12288, v24
    v_add_u32 v27, 12288, v25
    s_lshl2_add_u32 s42, s7, s68
    s_mul_i32 s42, s42, 28672
    s_lshl_b32 s43, s68, 14
    s_and_b32 s31, s6, 1
    s_mul_i32 s31, s31, 84
    s_add_u32 s31, s31, s68
    s_lshl_b32 s31, s31, 10
    s_add_u32 s31, s31, s99
    s_add_u32 s88, s31, 524288
    s_add_u32 s89, s88, 28672
    s_add_u32 s90, s88, 57344
    s_lshl_b32 s71, s68, 10
    v_and_b32 v5, 31, v0
    v_cmp_lt_u32 vcc, 11, v5
    s_nop 1
    v_subb_co_u32 v6, vcc, v5, 0, vcc
    v_cmp_lt_u32 vcc, 15, v5
    s_nop 1
    v_subb_co_u32 v6, vcc, v6, 0, vcc
    v_cmp_lt_u32 vcc, 27, v5
    s_nop 1
    v_subb_co_u32 v6, vcc, v6, 0, vcc
    s_cmp_eq_u32 s68, 1
    s_cselect_b64 vcc, -1, 0
    v_cndmask_b32 v5, v5, v6, vcc
    v_min_u32 v5, 27, v5
    v_bfe_u32 v10, v5, 2, 2
    v_add_u32 v8, 28, v10
    v_and_b32 v11, 1, v10
    v_lshlrev_b32 v11, 2, v11
    v_lshrrev_b32 v10, 1, v10
    v_lshl_add_u32 v11, v10, 4, v11
    v_add_u32 v11, 11, v11
    s_cmp_eq_u32 s68, 1
    s_cselect_b64 vcc, -1, 0
    v_cndmask_b32 v8, v8, v11, vcc
    v_bfe_u32 v10, v5, 4, 1
    v_lshl_add_u32 v8, v10, 5, v8
    v_lshrrev_b32 v10, 2, v5
    s_cmp_eq_u32 s68, 0
    s_cselect_b32 s82, 3, 99
    v_cmp_eq_u32 vcc, s82, v10
    v_mov_b32 v11, 1855
    v_and_b32 v10, 3, v5
    v_cndmask_b32 v8, v8, v11, vcc
    v_lshl_add_u32 v8, v8, 2, v10
    v_lshlrev_b32 v8, 2, v8
    s_min_u32 s31, s68, 2
    s_mul_i32 s31, s31, 28672
    s_add_u32 s31, s31, 65536
    v_lshrrev_b32 v3, 5, v0
    v_lshl_add_u32 v8, v3, 10, v8
    v_add_u32 v21, s31, v8
    s_add_u32 s31, s71, 151552
    s_cmp_eq_u32 s68, 3
    s_cselect_b32 s31, 157696, s31
    v_add_u32 v22, s31, v1
    s_mov_b32 s34, s28
    s_mov_b32 s35, s29
    s_lshl2_add_u32 s28, s2, s68
    s_mul_i32 s29, s28, 9363
    s_lshr_b32 s29, s29, 16
    s_mul_i32 s30, s29, 7
    s_sub_u32 s30, s28, s30
    s_sub_u32 s31, s29, 32
    s_cmp_lt_u32 s29, 32
    s_cselect_b32 s36, s40, s48
    s_cselect_b32 s37, s41, s49
    s_cselect_b32 s38, 1, 4
    s_cselect_b32 s29, s29, s31
    s_cselect_b32 s31, 14, 16
    s_cselect_b32 s79, 35, 114
    s_cselect_b32 s63, 0xffff, -1
    s_cselect_b32 s32, 3, 4
    s_cselect_b32 s78, 0, 524288
    s_mul_i32 s38, s38, 401408
    s_mov_b32 s39, 0x20000
    s_lshl_b32 s79, s79, 10
    s_lshl_b32 s32, s32, 7
    s_mul_i32 s31, s31, s29
    s_mul_i32 s31, s31, 896
    s_lshl_b32 s33, s30, 7
    s_add_u32 s87, s31, s33
    s_cmp_ge_u32 s29, 56
    s_cselect_b32 s33, 1, 0
    s_add_u32 s29, s29, s33
    s_lshl_b32 s29, s29, 10
    s_add_u32 s78, s78, s29
    s_mul_i32 s30, s30, s79
    s_lshl1_add_u32 s78, s30, s78
    s_add_u32 s78, s78, 1048576
    s_cmp_lt_u32 s28, 1008
    s_cselect_b32 s78, s78, 1073741824
    s_add_u32 s55, s78, s79
    v_lshrrev_b32 v3, 3, v0
    v_and_b32 v4, 7, v0
    v_mul_u32_u24 v5, 896, v3
    v_lshl_add_u32 v90, v4, 4, v5
    s_lshr_b32 s31, s68, 1
    s_mul_i32 s31, s31, 12288
    s_lshl_b32 s33, s68, 11
    s_add_u32 s31, s31, s33
    s_add_u32 s31, s31, 28672
    s_mov_b32 s91, s31
    v_lshrrev_b32 v3, 5, v0
    v_bfe_u32 v4, v0, 2, 2
    v_lshlrev_b32 v4, 7, v4
    v_bfe_u32 v5, v0, 4, 1
    v_lshl_add_u32 v4, v5, 5, v4
    v_and_b32 v5, 3, v0
    v_lshl_add_u32 v4, v5, 3, v4
    v_add_u32 v4, s31, v4
    v_lshl_add_u32 v91, v3, 9, v4
    v_mad_u32_u24 v92, v3, s32, v4
    s_lshl2_add_u32 s100, s2, s68
    s_mul_i32 s100, s100, 1664
    v_min_u32 v93, 12, v0
    v_lshlrev_b32 v93, 7, v93
    s_lshl_b32 s101, s2, 7
    s_and_b32 s28, s101, 0x1f80
    s_add_u32 s28, s28, 32768
    s_cmp_eq_u32 s68, 0
    s_cselect_b32 s101, s101, s28
    s_add_u32 s101, s101, 131072
    s_cmp_eq_u32 s68, 1
    s_cselect_b32 s101, s101, 1073741824
    s_mov_b32 s28, s34
    s_mov_b32 s29, s35
    s_mov_b32 s30, 96
    v_lshlrev_b32 v4, 3, v0
LB_wpoll:
    buffer_load_dwordx2 v[6:7], v4, s[12:15], s28 offen sc1
    s_sub_u32 s30, s30, 1
    s_cbranch_scc1 LB_wglob
    s_waitcnt vmcnt(0)
    v_cmp_ne_u32 vcc, s25, v6
    v_cmp_ne_u32 s[82:83], s25, v7
    s_nop 1
    s_or_b64 vcc, vcc, s[82:83]
    s_cbranch_scc1 LB_wpoll
LB_wdone:
    s_lshl_b32 s29, s56, 12
    s_add_u32 m0, s71, 65536
    s_add_u32 s29, s29, s88
    buffer_load_dwordx4 v1, s[12:15], s29 offen sc1 lds
    s_lshl_b32 s29, s56, 12
    s_add_u32 m0, s71, 94208
    s_add_u32 s29, s29, s89
    buffer_load_dwordx4 v1, s[12:15], s29 offen sc1 lds
    s_lshl_b32 s29, s57, 12
    s_add_u32 m0, s71, 69632
    s_add_u32 s29, s29, s88
    buffer_load_dwordx4 v1, s[12:15], s29 offen sc1 lds
    s_lshl_b32 s29, s57, 12
    s_add_u32 m0, s71, 98304
    s_add_u32 s29, s29, s89
    buffer_load_dwordx4 v1, s[12:15], s29 offen sc1 lds
    s_lshl_b32 s29, s58, 12
    s_add_u32 m0, s71, 73728
    s_add_u32 s29, s29, s88
    buffer_load_dwordx4 v1, s[12:15], s29 offen sc1 lds
    s_lshl_b32 s29, s58, 12
    s_add_u32 m0, s71, 102400
    s_add_u32 s29, s29, s89
    buffer_load_dwordx4 v1, s[12:15], s29 offen sc1 lds
    s_barrier
    s_lshl_b32 s29, s59, 7
    s_add_u32 m0, s43, 12288
    s_add_u32 s29, s29, s42
    buffer_load_dwordx4 v24, s[8:11], s29 offen offset:0 lds
    v_mov_b32 v3, s26
    v_mov_b32 v4, 154624
    ds_write_b32 v4, v3
    s_waitcnt lgkmcnt(0)
    buffer_load_dwordx4 v25, s[8:11], s29 offen offset:1024 lds
    buffer_load_dwordx4 v26, s[8:11], s29 offen offset:2048 lds
    buffer_load_dwordx4 v27, s[8:11], s29 offen offset:3072 lds
    s_waitcnt vmcnt(6)
    s_barrier
    s_lshl_b32 s29, s59, 12
    s_add_u32 m0, s71, 77824
    s_add_u32 s29, s29, s88
    buffer_load_dwordx4 v1, s[12:15], s29 offen sc1 lds
    s_lshl_b32 s29, s59, 12
    s_add_u32 m0, s71, 106496
    s_add_u32 s29, s29, s89
    buffer_load_dwordx4 v1, s[12:15], s29 offen sc1 lds
    s_lshl_b32 s29, s60, 7
    s_add_u32 m0, s43, 0
    s_add_u32 s29, s29, s42
    buffer_load_dwordx4 v24, s[8:11], s29 offen offset:0 lds
    buffer_load_dwordx4 v25, s[8:11], s29 offen offset:1024 lds
    buffer_load_dwordx4 v26, s[8:11], s29 offen offset:2048 lds
    buffer_load_dwordx4 v27, s[8:11], s29 offen offset:3072 lds
    s_waitcnt vmcnt(10)
    s_barrier
    s_lshl_b32 s29, s60, 12
    s_add_u32 m0, s71, 81920
    s_add_u32 s29, s29, s88
    buffer_load_dwordx4 v1, s[12:15], s29 offen sc1 lds
    s_lshl_b32 s29, s60, 12
    s_add_u32 m0, s71, 110592
    s_add_u32 s29, s29, s89
    buffer_load_dwordx4 v1, s[12:15], s29 offen sc1 lds
    s_lshl_b32 s29, s61, 7
    s_add_u32 m0, s43, 4096
    s_add_u32 s29, s29, s42
    buffer_load_dwordx4 v24, s[8:11], s29 offen offset:0 lds
    buffer_load_dwordx4 v25, s[8:11], s29 offen offset:1024 lds
    buffer_load_dwordx4 v26, s[8:11], s29 offen offset:2048 lds
    buffer_load_dwordx4 v27, s[8:11], s29 offen offset:3072 lds
    s_waitcnt vmcnt(10)
    s_barrier
    s_lshl_b32 s29, s61, 12
    s_add_u32 m0, s71, 86016
    s_add_u32 s29, s29, s88
    buffer_load_dwordx4 v1, s[12:15], s29 offen sc1 lds
    s_lshl_b32 s29, s61, 12
    s_add_u32 m0, s71, 114688
    s_add_u32 s29, s29, s89
    buffer_load_dwordx4 v1, s[12:15], s29 offen sc1 lds
    s_lshl_b32 s29, s62, 7
    s_add_u32 m0, s43, 8192
    s_add_u32 s29, s29, s42
    buffer_load_dwordx4 v24, s[8:11], s29 offen offset:0 lds
    buffer_load_dwordx4 v25, s[8:11], s29 offen offset:1024 lds
    buffer_load_dwordx4 v26, s[8:11], s29 offen offset:2048 lds
    buffer_load_dwordx4 v27, s[8:11], s29 offen offset:3072 lds
    s_waitcnt vmcnt(10)
    s_barrier
    s_lshl_b32 s29, s62, 12
    s_add_u32 m0, s71, 90112
    s_add_u32 s29, s29, s88
    buffer_load_dwordx4 v1, s[12:15], s29 offen sc1 lds
    s_lshl_b32 s29, s62, 12
    s_add_u32 m0, s71, 118784
    s_add_u32 s29, s29, s89
    buffer_load_dwordx4 v1, s[12:15], s29 offen sc1 lds
    s_lshl_b32 s29, s56, 12
    s_add_u32 m0, s71, 122880
    s_add_u32 s29, s29, s90
    buffer_load_dwordx4 v1, s[12:15], s29 offen sc1 lds
    s_lshl_b32 s29, s57, 12
    s_add_u32 m0, s71, 126976
    s_add_u32 s29, s29, s90
    buffer_load_dwordx4 v1, s[12:15], s29 offen sc1 lds
    s_lshl_b32 s29, s58, 12
    s_add_u32 m0, s71, 131072
    s_add_u32 s29, s29, s90
    buffer_load_dwordx4 v1, s[12:15], s29 offen sc1 lds
    s_lshl_b32 s29, s59, 12
    s_add_u32 m0, s71, 135168
    s_add_u32 s29, s29, s90
    buffer_load_dwordx4 v1, s[12:15], s29 offen sc1 lds
    s_waitcnt vmcnt(10)
    s_barrier
    s_lshl_b32 s29, s60, 12
    s_add_u32 m0, s71, 139264
    s_add_u32 s29, s29, s90
    buffer_load_dwordx4 v1, s[12:15], s29 offen sc1 lds
    s_lshl_b32 s29, s61, 12
    s_add_u32 m0, s71, 143360
    s_add_u32 s29, s29, s90
    buffer_load_dwordx4 v1, s[12:15], s29 offen sc1 lds
    s_lshl_b32 s29, s62, 12
    s_add_u32 m0, s71, 147456
    s_add_u32 s29, s29, s90
    buffer_load_dwordx4 v1, s[12:15], s29 offen sc1 lds
    s_lshl2_add_u32 s29, s7, s68
    s_lshl_b32 s29, s29, 12
    s_add_u32 s29, s29, s69
    v_lshrrev_b32 v3, 1, v0
    v_lshlrev_b32 v3, 7, v3
    buffer_load_dword v110, v3, s[12:15], s29 offen sc1
    s_waitcnt vmcnt(8)
    s_barrier
    s_cmp_ge_u32 s68, 2
    s_cbranch_scc1 LB_nocs
    ds_read2st64_b32 v[32:33], v21 offset0:0 offset1:8
    ds_read2st64_b32 v[34:35], v21 offset0:16 offset1:24
    ds_read2st64_b32 v[36:37], v21 offset0:32 offset1:40
    ds_read2st64_b32 v[38:39], v21 offset0:48 offset1:56
    ds_read2st64_b32 v[40:41], v21 offset0:64 offset1:72
    ds_read2st64_b32 v[42:43], v21 offset0:80 offset1:88
    ds_read2st64_b32 v[44:45], v21 offset0:96 offset1:104
    s_waitcnt lgkmcnt(0)
    v_add_f32 v32, v32, v34
    v_add_f32 v33, v33, v35
    v_add_f32 v32, v32, v36
    v_add_f32 v33, v33, v37
    v_add_f32 v32, v32, v38
    v_add_f32 v33, v33, v39
    v_add_f32 v32, v32, v40
    v_add_f32 v33, v33, v41
    v_add_f32 v32, v32, v42
    v_add_f32 v33, v33, v43
    v_add_f32 v32, v32, v44
    v_add_f32 v33, v33, v45
    v_add_f32 v32, v32, v33
    v_cvt_pk_bf16_f32 v4, v32, v32
    v_mov_b32 v10, 0
    v_mov_b32 v11, 0
    v_and_b32 v5, 0xffff0000, v4
    v_and_b32 v9, 0xffff, v4
    v_sub_f32 v5, v32, v5
    v_cvt_pk_bf16_f32 v8, v32, v5
    ds_write_b128 v22, v[8:11]
LB_nocs:
    s_waitcnt vmcnt(1)
    s_waitcnt lgkmcnt(0)
    s_barrier
    s_cmp_lt_u32 s68, 2
    s_cbranch_scc1 LB_nocs2
    ds_read2st64_b32 v[32:33], v21 offset0:0 offset1:8
    ds_read2st64_b32 v[34:35], v21 offset0:16 offset1:24
    ds_read2st64_b32 v[36:37], v21 offset0:32 offset1:40
    ds_read2st64_b32 v[38:39], v21 offset0:48 offset1:56
    ds_read2st64_b32 v[40:41], v21 offset0:64 offset1:72
    ds_read2st64_b32 v[42:43], v21 offset0:80 offset1:88
    ds_read2st64_b32 v[44:45], v21 offset0:96 offset1:104
    s_waitcnt lgkmcnt(0)
    v_add_f32 v32, v32, v34
    v_add_f32 v33, v33, v35
    v_add_f32 v32, v32, v36
    v_add_f32 v33, v33, v37
    v_add_f32 v32, v32, v38
    v_add_f32 v33, v33, v39
    v_add_f32 v32, v32, v40
    v_add_f32 v33, v33, v41
    v_add_f32 v32, v32, v42
    v_add_f32 v33, v33, v43
    v_add_f32 v32, v32, v44
    v_add_f32 v33, v33, v45
    v_add_f32 v32, v32, v33
    v_cvt_pk_bf16_f32 v4, v32, v32
    v_mov_b32 v10, 0
    v_mov_b32 v11, 0
    v_and_b32 v5, 0xffff0000, v4
    v_and_b32 v9, 0xffff, v4
    v_sub_f32 v5, v32, v5
    v_cvt_pk_bf16_f32 v8, v32, v5
    ds_write_b128 v22, v[8:11]
LB_nocs2:
    s_waitcnt lgkmcnt(0)
    s_and_b32 s32, s72, 7
    s_lshl2_add_u32 s32, s32, s68
    s_lshl_b32 s32, s32, 13
    s_add_u32 s32, s32, s99
    s_add_u32 s32, s32, 786432
    s_and_b32 s42, s5, 3
    s_lshl_b32 s42, s42, 7
    s_sub_u32 s32, s32, s42
    s_add_u32 s42, s12, s32
    s_addc_u32 s43, s13, 0
    s_load_dword s56, s[42:43], 2044 glc
    s_load_dword s57, s[42:43], 4092 glc
    s_load_dword s58, s[42:43], 6140 glc
    s_load_dword s59, s[42:43], 8188 glc
    s_setprio 0
    s_lshl_b32 s71, s68, 12
    s_add_u32 s69, s69, s71
    s_lshl_b32 s54, s7, 14
    v_add_u32 v4, 8192, v1
    v_add_u32 v5, 73728, v1
    v_add_u32 v6, 139264, v1
    v_mov_b32 v7, 0xdddddddd
    v_add_u32 v96, s69, v1
    s_and_b32 s28, s68, 1
    s_lshl1_add_u32 s28, s77, s28
    s_lshr_b32 s31, s68, 1
    s_lshl1_add_u32 s28, s28, s31
    s_mul_i32 s95, s28, 58368
    s_add_u32 s95, s95, 1572864
    s_cmp_lt_u32 s5, 28
    s_cselect_b32 s95, s95, 1073741824
    v_lshlrev_b32 v94, 7, v0
    s_lshl2_add_u32 s28, s5, s68
    s_mul_i32 s28, s28, 14
    v_min_u32 v12, 13, v0
    v_add_u32 v12, s28, v12
    v_lshrrev_b32 v95, 6, v12
    v_mul_u32_u24 v95, 58368, v95
    v_and_b32 v12, 63, v12
    v_lshl_add_u32 v95, v12, 7, v95
    v_lshlrev_b32 v94, 7, v0
    s_mul_i32 s28, s72, 28
    s_lshl1_add_u32 s28, s73, s28
    s_lshl_b32 s28, s28, 10
    s_add_u32 s28, s28, 3670016
    v_add_u32 v111, s28, v94
    s_lshl2_add_u32 s29, s5, s68
    s_mul_i32 s28, s29, 1280
    s_add_u32 s28, s28, s99
    s_add_u32 s28, s28, 522240
    v_add_u32 v14, s28, v94
    v_cmp_lt_u32 vcc, 15, v0
    s_lshl_b32 s28, s4, 7
    s_add_u32 s28, s28, s29
    v_cndmask_b32 v111, v111, v14, vcc
    s_lshl_b32 s28, s28, 8
    s_add_u32 s28, s28, 3404544
    v_add_u32 v14, s28, v94
    v_cmp_lt_u32 vcc, 25, v0
    s_and_b32 s28, s29, 7
    s_lshl3_add_u32 s28, s4, s28
    v_cndmask_b32 v111, v111, v14, vcc
    s_lshl_b32 s28, s28, 7
    s_bitcmp1_b32 s29, 3
    s_cselect_b32 s29, 8192, 0
    s_add_u32 s28, s28, s29
    s_add_u32 s28, s28, 16384
    v_cmp_lt_u32 vcc, 27, v0
    v_mov_b32 v14, s28
    s_nop 0
    v_cndmask_b32 v111, v111, v14, vcc
    v_lshrrev_b32 v12, 4, v0
    v_and_b32 v14, 15, v0
    v_lshlrev_b32 v14, 4, v14
    v_lshl_add_u32 v14, v12, 9, v14
    v_mul_u32_u24 v109, 0x410000, v0
    v_xor_b32 v109, s24, v109
    v_and_b32 v109, 0x9fff0000, v109
    v_or_b32 v109, 0x20000000, v109
    v_mov_b32 v16, 0
    v_mov_b32 v17, 0
    v_mov_b32 v18, 0
    v_mov_b32 v19, 0
    v_mov_b32 v20, 0
    v_mov_b32 v21, 0
    v_mov_b32 v22, 0
    v_mov_b32 v23, 0
    v_mov_b32 v24, 0
    v_mov_b32 v25, 0
    v_mov_b32 v26, 0
    v_mov_b32 v27, 0
    v_mov_b32 v28, 0
    v_mov_b32 v29, 0
    v_mov_b32 v30, 0
    v_mov_b32 v31, 0
    s_mov_b32 s20, s44
    s_mov_b32 s21, s45
    s_mov_b32 s22, 1605632
    s_mov_b32 s23, 0x20000
    s_mul_i32 s70, s68, 57344
    s_lshl_b32 s29, s75, 8
    s_add_u32 s70, s70, s29
    s_cmp_lt_u32 s5, 28
    s_cselect_b32 s70, s70, 1073741824
    s_cmp_eq_u32 s3, 7
    s_cselect_b32 s86, 163840, 1073741824
    s_cselect_b32 s80, s24, 0
    s_lshl_b32 s79, s68, 12
    s_lshl_b32 s32, s68, 11
    s_add_u32 s32, s32, 32768
    v_add_u32 v9, s32, v1
    v_lshrrev_b32 v10, 4, v0
    v_and_b32 v11, 15, v0
    v_lshlrev_b32 v12, 2, v10
    v_xor_b32 v11, v11, v12
    v_mul_u32_u24 v10, 3584, v10
    v_lshl_add_u32 v89, v11, 4, v10
    v_xor_b32 v88, 16, v89
    s_lshl_b32 s28, s6, 8
    s_add_u32 s28, s28, 8192
    v_lshlrev_b32 v3, 2, v0
    s_branch LB_att
    .fill 400, 4, 0xbf800000
LA_start:
    s_and_b32 s28, s5, 1
    s_lshl1_add_u32 s6, s4, s28
    s_lshr_b32 s7, s5, 1
    s_mul_i32 s28, s28, 0
    s_mul_i32 s29, s4, 1
    s_add_u32 s28, s28, s29
    s_mul_i32 s29, s28, 37
    s_lshr_b32 s29, s29, 8
    s_mul_i32 s29, s29, 7
    s_sub_u32 s56, s28, s29
    s_add_u32 s57, s56, 1
    s_cmp_eq_u32 s57, 7
    s_cselect_b32 s57, 0, s57
    s_add_u32 s58, s57, 1
    s_cmp_eq_u32 s58, 7
    s_cselect_b32 s58, 0, s58
    s_add_u32 s59, s58, 1
    s_cmp_eq_u32 s59, 7
    s_cselect_b32 s59, 0, s59
    s_add_u32 s60, s59, 1
    s_cmp_eq_u32 s60, 7
    s_cselect_b32 s60, 0, s60
    s_add_u32 s61, s60, 1
    s_cmp_eq_u32 s61, 7
    s_cselect_b32 s61, 0, s61
    s_add_u32 s62, s61, 1
    s_cmp_eq_u32 s62, 7
    s_cselect_b32 s62, 0, s62
    v_lshrrev_b32 v3, 3, v0
    v_and_b32 v4, 7, v0
    v_lshrrev_b32 v5, 1, v3
    v_xor_b32 v4, v4, v5
    v_mul_u32_u24 v3, 896, v3
    v_lshl_add_u32 v240, v4, 4, v3
    v_xor_b32 v241, 64, v240
    v_add_u32 v241, 6144, v241
    v_add_u32 v242, 12288, v240
    v_add_u32 v243, 12288, v241
    s_lshl2_add_u32 s28, s7, s68
    s_mul_i32 s28, s28, 28672
    s_lshl_b32 s71, s68, 14
    s_waitcnt lgkmcnt(0)
    s_mov_b32 s8, s36
    s_mov_b32 s9, s37
    s_mov_b32 s10, 1835008
    s_mov_b32 s11, 0x20000
    buffer_load_dword v251, v2, s[12:15], 0 offen sc1
    s_lshl_b32 s29, s56, 7
    s_add_u32 m0, s71, 0
    s_add_u32 s29, s29, s28
    buffer_load_dwordx4 v240, s[8:11], s29 offen offset:0 lds
    buffer_load_dwordx4 v241, s[8:11], s29 offen offset:1024 lds
    buffer_load_dwordx4 v242, s[8:11], s29 offen offset:2048 lds
    buffer_load_dwordx4 v243, s[8:11], s29 offen offset:3072 lds
    s_lshl_b32 s29, s57, 7
    s_add_u32 m0, s71, 4096
    s_add_u32 s29, s29, s28
    buffer_load_dwordx4 v240, s[8:11], s29 offen offset:0 lds
    s_load_dwordx8 s[40:47], s[0:1], 16
    s_load_dwordx4 s[48:51], s[0:1], 48
    s_load_dwordx2 s[52:53], s[0:1], 64
    s_mov_b32 s64, 0
    s_mov_b32 s65, -1
    s_mov_b32 s66, 0x88008800
    s_mov_b32 s67, 0x88008800
    s_mov_b32 s27, 0x20000
    s_mov_b32 s92, 0x3f803f80
    s_getreg_b32 s25, hwreg(HW_REG_XCC_ID, 0, 4)
    s_lshr_b32 s30, s5, 2
    s_lshl3_add_u32 s72, s4, s30
    s_and_b32 s30, s5, 3
    s_lshl2_add_u32 s73, s30, s68
    s_cmp_ge_u32 s5, 14
    s_cselect_b32 s30, 1, 0
    s_mul_i32 s31, s30, 14
    s_sub_u32 s75, s5, s31
    s_lshl1_add_u32 s30, s4, s30
    s_lshl2_add_u32 s74, s30, s68
    s_mul_i32 s30, s5, 37
    s_lshr_b32 s30, s30, 8
    s_mul_i32 s31, s30, 7
    s_sub_u32 s77, s5, s31
    s_lshl2_add_u32 s30, s4, s30
    s_lshl_b32 s76, s30, 1
    s_and_b32 s69, s6, 1
    s_lshl_b32 s69, s69, 18
    s_add_u32 s69, s69, s99
    s_waitcnt lgkmcnt(0)
    v_and_b32 v3, 31, v0
    v_lshrrev_b32 v4, 5, v0
    v_bfe_u32 v5, v3, 1, 3
    v_xor_b32 v5, v5, v4
    v_lshlrev_b32 v6, 7, v3
    v_lshl_add_u32 v6, v5, 4, v6
    v_add_u32 v244, s71, v6
    v_xor_b32 v245, 32, v244
    v_xor_b32 v246, 64, v244
    v_xor_b32 v247, 0x60, v244
    v_mov_b32 v248, 0
    v_mov_b32 v249, 0
    v_add_u32 v252, 65536, v1
    v_mov_b32 v254, s92
    v_bfe_u32 v5, v3, 2, 1
    v_bfe_u32 v6, v3, 3, 1
    v_and_b32 v7, 0x33, v0
    v_lshl_or_b32 v7, v5, 3, v7
    v_lshl_or_b32 v7, v6, 2, v7
    v_lshlrev_b32 v253, 4, v7
    s_lshl_b32 s32, s3, 7
    s_add_u32 s32, s32, 155648
    v_lshl_add_u32 v10, v3, 2, s32
    v_lshl_add_u32 v11, v4, 4, s32
    v_lshlrev_b32 v12, 7, v3
    s_lshl2_add_u32 s33, s7, s3
    s_lshl_b32 s30, s33, 12
    s_add_u32 s30, s30, s69
    s_lshl_b32 s31, s6, 6
    s_add_u32 s31, s31, s33
    s_lshl_b32 s31, s31, 2
    s_add_u32 s31, s31, 8192
    s_lshl_b32 s32, s3, 12
    v_add_u32 v4, s32, v253
    v_add_u32 v5, s32, v1
    s_lshl_b32 s32, s3, 11
    s_add_u32 s32, s32, 32768
    v_add_u32 v6, s32, v1
    v_add_u32 v7, 57344, v252
    v_mov_b32 v13, 0x40000
    v_add_u32 v101, 151552, v1
    v_cndmask_b32 v12, v252, v13, s[66:67]
    s_mov_b32 vcc_lo, 0xf0000000
    s_mov_b32 vcc_hi, 0xf0000000
    v_cndmask_b32 v7, v7, v13, vcc
    s_mov_b32 vcc_lo, 0x70000000
    s_mov_b32 vcc_hi, 0x70000000
    v_cndmask_b32 v252, v252, v13, vcc
    v_mov_b32 v8, 154624
    s_and_b32 s78, s2, 63
    s_lshl_b32 s78, s78, 5
    s_lshr_b32 s32, s2, 6
    s_add_u32 s78, s78, s32
    s_lshl_b32 s78, s78, 2
    s_add_u32 s78, s78, 163840
    s_cmp_eq_u32 s3, 0
    s_cselect_b32 s78, s78, 1073741824
    s_barrier
    buffer_load_dwordx4 v241, s[8:11], s29 offen offset:1024 lds
    buffer_load_dwordx4 v242, s[8:11], s29 offen offset:2048 lds
    buffer_load_dwordx4 v243, s[8:11], s29 offen offset:3072 lds
    s_lshl_b32 s29, s58, 7
    s_add_u32 m0, s71, 8192
    s_add_u32 s29, s29, s28
    buffer_load_dwordx4 v240, s[8:11], s29 offen offset:0 lds
    buffer_load_dwordx4 v241, s[8:11], s29 offen offset:1024 lds
    buffer_load_dwordx4 v242, s[8:11], s29 offen offset:2048 lds
    buffer_load_dwordx4 v243, s[8:11], s29 offen offset:3072 lds
    s_mul_i32 s70, s73, 35840
    s_add_u32 s70, s70, 1048576
    s_cmp_lt_u32 s73, 14
    s_cselect_b32 s70, s70, 1073741824
    v_lshrrev_b32 v240, 2, v0
    v_mul_u32_u24 v240, 896, v240
    v_and_b32 v241, 3, v0
    v_lshl_add_u32 v240, v241, 4, v240
    v_add_u32 v241, 14336, v240
    s_mul_i32 s79, s72, 28672
    s_lshl_b32 s29, s73, 6
    s_add_u32 s79, s79, s29
    s_lshl2_add_u32 s28, s75, s68
    s_lshl_b32 s81, s28, 6
    v_and_b32 v242, 31, v0
    v_lshlrev_b32 v242, 1, v242
    s_mov_b32 s16, s46
    s_mov_b32 s17, s47
    s_mov_b32 s18, 3584
    s_mov_b32 s19, 0x20000
    s_mov_b32 s20, s50
    s_mov_b32 s21, s51
    s_mov_b32 s22, 896
    s_mov_b32 s23, 0x20000
    s_lshl_b32 s71, s68, 12
    s_add_u32 s69, s69, s71
    s_lshl_b32 s54, s7, 14
    s_waitcnt vmcnt(12)
    v_readfirstlane_b32 s82, v251
    s_add_u32 s25, s25, 1
    s_lshl_b32 s25, s25, 27
    s_mul_i32 s24, s82, 0x9E3779B1
    s_add_u32 s24, s24, 0x7F4A7C15
    s_xor_b32 s82, s82, s24
    s_and_b32 s82, s82, 0x9fff0000
    s_cselect_b32 s82, 0, 0x10000
    s_xor_b32 s24, s24, s82
    s_xor_b32 s25, s25, s24
    s_waitcnt vmcnt(8)
    ds_read_b128 v[128:131], v244 offset:0
    ds_read_b128 v[132:135], v245 offset:0
    ds_read_b128 v[136:139], v246 offset:0
    ds_read_b128 v[140:143], v247 offset:0
    s_waitcnt vmcnt(4)
    ds_read_b128 v[144:147], v244 offset:4096
    ds_read_b128 v[148:151], v245 offset:4096
    ds_read_b128 v[152:155], v246 offset:4096
    ds_read_b128 v[156:159], v247 offset:4096
    s_waitcnt lgkmcnt(4)
    v_dot2c_f32_bf16 v248, v128, v128
    v_dot2c_f32_bf16 v249, v129, v129
    v_dot2c_f32_bf16 v248, v130, v130
    v_dot2c_f32_bf16 v249, v131, v131
    v_dot2c_f32_bf16 v248, v132, v132
    v_dot2c_f32_bf16 v249, v133, v133
    v_dot2c_f32_bf16 v248, v134, v134
    v_dot2c_f32_bf16 v249, v135, v135
    v_dot2c_f32_bf16 v248, v136, v136
    v_dot2c_f32_bf16 v249, v137, v137
    v_dot2c_f32_bf16 v248, v138, v138
    v_dot2c_f32_bf16 v249, v139, v139
    v_dot2c_f32_bf16 v248, v140, v140
    v_dot2c_f32_bf16 v249, v141, v141
    v_dot2c_f32_bf16 v248, v142, v142
    v_dot2c_f32_bf16 v249, v143, v143
    s_waitcnt vmcnt(0)
    ds_read_b128 v[160:163], v244 offset:8192
    ds_read_b128 v[164:167], v245 offset:8192
    ds_read_b128 v[168:171], v246 offset:8192
    ds_read_b128 v[172:175], v247 offset:8192
    s_waitcnt lgkmcnt(4)
    v_dot2c_f32_bf16 v248, v144, v144
    v_dot2c_f32_bf16 v249, v145, v145
    v_dot2c_f32_bf16 v248, v146, v146
    v_dot2c_f32_bf16 v249, v147, v147
    v_dot2c_f32_bf16 v248, v148, v148
    v_dot2c_f32_bf16 v249, v149, v149
    v_dot2c_f32_bf16 v248, v150, v150
    v_dot2c_f32_bf16 v249, v151, v151
    v_dot2c_f32_bf16 v248, v152, v152
    v_dot2c_f32_bf16 v249, v153, v153
    v_dot2c_f32_bf16 v248, v154, v154
    v_dot2c_f32_bf16 v249, v155, v155
    v_dot2c_f32_bf16 v248, v156, v156
    v_dot2c_f32_bf16 v249, v157, v157
    v_dot2c_f32_bf16 v248, v158, v158
    v_dot2c_f32_bf16 v249, v159, v159
    s_waitcnt lgkmcnt(0)
    v_mov_b32 v255, 0x3f80
    v_bfe_u32 v251, v0, 4, 1
    v_add_u32 v251, -1, v251
    v_and_b32 v251, s92, v251
    s_barrier
    v_dot2c_f32_bf16 v248, v160, v160
    v_dot2c_f32_bf16 v249, v161, v161
    v_dot2c_f32_bf16 v248, v162, v162
    v_dot2c_f32_bf16 v249, v163, v163
    v_dot2c_f32_bf16 v248, v164, v164
    v_dot2c_f32_bf16 v249, v165, v165
    v_dot2c_f32_bf16 v248, v166, v166
    v_dot2c_f32_bf16 v249, v167, v167
    v_dot2c_f32_bf16 v248, v168, v168
    v_dot2c_f32_bf16 v249, v169, v169
    v_dot2c_f32_bf16 v248, v170, v170
    v_dot2c_f32_bf16 v249, v171, v171
    v_dot2c_f32_bf16 v248, v172, v172
    v_dot2c_f32_bf16 v249, v173, v173
    v_dot2c_f32_bf16 v248, v174, v174
    v_dot2c_f32_bf16 v249, v175, v175
    s_barrier
    ds_read_b32 v14, v8
    ds_read_b128 v[64:67], v252 offset:0
    ds_read_b128 v[68:71], v12 offset:28672
    ds_read_b128 v[72:75], v252 offset:1024
    ds_read_b128 v[76:79], v12 offset:29696
    ds_read_b128 v[80:83], v252 offset:2048
    ds_read_b128 v[84:87], v12 offset:30720
    ds_read_b128 v[88:91], v252 offset:3072
    s_setprio 1
    s_waitcnt lgkmcnt(7)
    v_readfirstlane_b32 s26, v14
    s_waitcnt lgkmcnt(5)
    v_mfma_f32_32x32x16_bf16 v[16:31], v[64:67], v[128:131], 0
    ds_read_b128 v[92:95], v12 offset:31744
    v_mfma_f32_32x32x16_bf16 v[32:47], v[128:131], v[68:71], 0
    ds_read_b128 v[64:67], v252 offset:4096
    s_waitcnt lgkmcnt(5)
    v_mfma_f32_32x32x16_bf16 v[16:31], v[72:75], v[132:135], v[16:31]
    ds_read_b128 v[68:71], v12 offset:32768
    v_mfma_f32_32x32x16_bf16 v[32:47], v[132:135], v[76:79], v[32:47]
    ds_read_b128 v[72:75], v252 offset:5120
    s_waitcnt lgkmcnt(5)
    v_mfma_f32_32x32x16_bf16 v[16:31], v[80:83], v[136:139], v[16:31]
    ds_read_b128 v[76:79], v12 offset:33792
    v_mfma_f32_32x32x16_bf16 v[32:47], v[136:139], v[84:87], v[32:47]
    ds_read_b128 v[80:83], v252 offset:6144
    s_waitcnt lgkmcnt(5)
    v_mfma_f32_32x32x16_bf16 v[16:31], v[88:91], v[140:143], v[16:31]
    ds_read_b128 v[84:87], v12 offset:34816
    v_mfma_f32_32x32x16_bf16 v[32:47], v[140:143], v[92:95], v[32:47]
    ds_read_b128 v[88:91], v252 offset:7168
    s_waitcnt lgkmcnt(5)
    v_mfma_f32_32x32x16_bf16 v[16:31], v[64:67], v[144:147], v[16:31]
    ds_read_b128 v[92:95], v12 offset:35840
    v_mfma_f32_32x32x16_bf16 v[32:47], v[144:147], v[68:71], v[32:47]
    s_barrier
    ds_read_b128 v[64:67], v252 offset:8192
    s_waitcnt lgkmcnt(5)
    v_mfma_f32_32x32x16_bf16 v[16:31], v[72:75], v[148:151], v[16:31]
    ds_read_b128 v[68:71], v12 offset:36864
    v_mfma_f32_32x32x16_bf16 v[32:47], v[148:151], v[76:79], v[32:47]
    ds_read_b128 v[72:75], v252 offset:9216
    s_waitcnt lgkmcnt(5)
    v_mfma_f32_32x32x16_bf16 v[16:31], v[80:83], v[152:155], v[16:31]
    ds_read_b128 v[76:79], v12 offset:37888
    v_mfma_f32_32x32x16_bf16 v[32:47], v[152:155], v[84:87], v[32:47]
    ds_read_b128 v[80:83], v252 offset:10240
    s_waitcnt lgkmcnt(5)
    v_mfma_f32_32x32x16_bf16 v[16:31], v[88:91], v[156:159], v[16:31]
    ds_read_b128 v[84:87], v12 offset:38912
    v_mfma_f32_32x32x16_bf16 v[32:47], v[156:159], v[92:95], v[32:47]
    ds_read_b128 v[88:91], v252 offset:11264
    s_waitcnt lgkmcnt(5)
    v_mfma_f32_32x32x16_bf16 v[16:31], v[64:67], v[160:163], v[16:31]
    ds_read_b128 v[92:95], v12 offset:39936
    v_mfma_f32_32x32x16_bf16 v[32:47], v[160:163], v[68:71], v[32:47]
    s_barrier
    ds_read_b128 v[176:179], v244 offset:12288
    ds_read_b128 v[180:183], v245 offset:12288
    ds_read_b128 v[184:187], v246 offset:12288
    ds_read_b128 v[188:191], v247 offset:12288
    ds_read_b128 v[64:67], v252 offset:12288
    s_waitcnt lgkmcnt(9)
    v_mfma_f32_32x32x16_bf16 v[16:31], v[72:75], v[164:167], v[16:31]
    ds_read_b128 v[68:71], v12 offset:40960
    v_mfma_f32_32x32x16_bf16 v[32:47], v[164:167], v[76:79], v[32:47]
    ds_read_b128 v[72:75], v252 offset:13312
    s_waitcnt lgkmcnt(3)
    v_dot2c_f32_bf16 v248, v176, v176
    v_dot2c_f32_bf16 v249, v177, v177
    v_dot2c_f32_bf16 v248, v178, v178
    v_dot2c_f32_bf16 v249, v179, v179
    v_dot2c_f32_bf16 v248, v180, v180
    v_dot2c_f32_bf16 v249, v181, v181
    v_dot2c_f32_bf16 v248, v182, v182
    v_dot2c_f32_bf16 v249, v183, v183
    v_dot2c_f32_bf16 v248, v184, v184
    v_dot2c_f32_bf16 v249, v185, v185
    v_dot2c_f32_bf16 v248, v186, v186
    v_dot2c_f32_bf16 v249, v187, v187
    v_dot2c_f32_bf16 v248, v188, v188
    v_dot2c_f32_bf16 v249, v189, v189
    v_dot2c_f32_bf16 v248, v190, v190
    v_dot2c_f32_bf16 v249, v191, v191
    v_mfma_f32_32x32x16_bf16 v[16:31], v[80:83], v[168:171], v[16:31]
    ds_read_b128 v[76:79], v12 offset:41984
    v_mfma_f32_32x32x16_bf16 v[32:47], v[168:171], v[84:87], v[32:47]
    ds_read_b128 v[80:83], v252 offset:14336
    v_mfma_f32_32x32x16_bf16 v[16:31], v[88:91], v[172:175], v[16:31]
    ds_read_b128 v[84:87], v12 offset:43008
    v_mfma_f32_32x32x16_bf16 v[32:47], v[172:175], v[92:95], v[32:47]
    ds_read_b128 v[88:91], v252 offset:15360
    s_waitcnt lgkmcnt(5)
    v_mfma_f32_32x32x16_bf16 v[16:31], v[64:67], v[176:179], v[16:31]
    ds_read_b128 v[92:95], v12 offset:44032
    v_mfma_f32_32x32x16_bf16 v[32:47], v[176:179], v[68:71], v[32:47]
    s_barrier
    ds_read_b128 v[192:195], v244 offset:0
    ds_read_b128 v[196:199], v245 offset:0
    ds_read_b128 v[200:203], v246 offset:0
    ds_read_b128 v[204:207], v247 offset:0
    ds_read_b128 v[64:67], v252 offset:16384
    s_waitcnt lgkmcnt(9)
    v_mfma_f32_32x32x16_bf16 v[16:31], v[72:75], v[180:183], v[16:31]
    ds_read_b128 v[68:71], v12 offset:45056
    v_mfma_f32_32x32x16_bf16 v[32:47], v[180:183], v[76:79], v[32:47]
    ds_read_b128 v[72:75], v252 offset:17408
    s_waitcnt lgkmcnt(3)
    v_dot2c_f32_bf16 v248, v192, v192
    v_dot2c_f32_bf16 v249, v193, v193
    v_dot2c_f32_bf16 v248, v194, v194
    v_dot2c_f32_bf16 v249, v195, v195
    v_dot2c_f32_bf16 v248, v196, v196
    v_dot2c_f32_bf16 v249, v197, v197
    v_dot2c_f32_bf16 v248, v198, v198
    v_dot2c_f32_bf16 v249, v199, v199
    v_dot2c_f32_bf16 v248, v200, v200
    v_dot2c_f32_bf16 v249, v201, v201
    v_dot2c_f32_bf16 v248, v202, v202
    v_dot2c_f32_bf16 v249, v203, v203
    v_dot2c_f32_bf16 v248, v204, v204
    v_dot2c_f32_bf16 v249, v205, v205
    v_dot2c_f32_bf16 v248, v206, v206
    v_dot2c_f32_bf16 v249, v207, v207
    v_mfma_f32_32x32x16_bf16 v[16:31], v[80:83], v[184:187], v[16:31]
    ds_read_b128 v[76:79], v12 offset:46080
    v_mfma_f32_32x32x16_bf16 v[32:47], v[184:187], v[84:87], v[32:47]
    ds_read_b128 v[80:83], v252 offset:18432
    v_mfma_f32_32x32x16_bf16 v[16:31], v[88:91], v[188:191], v[16:31]
    ds_read_b128 v[84:87], v12 offset:47104
    v_mfma_f32_32x32x16_bf16 v[32:47], v[188:191], v[92:95], v[32:47]
    ds_read_b128 v[88:91], v252 offset:19456
    s_waitcnt lgkmcnt(5)
    v_mfma_f32_32x32x16_bf16 v[16:31], v[64:67], v[192:195], v[16:31]
    ds_read_b128 v[92:95], v12 offset:48128
    v_mfma_f32_32x32x16_bf16 v[32:47], v[192:195], v[68:71], v[32:47]
    s_barrier
    ds_read_b128 v[208:211], v244 offset:4096
    ds_read_b128 v[212:215], v245 offset:4096
    ds_read_b128 v[216:219], v246 offset:4096
    ds_read_b128 v[220:223], v247 offset:4096
    ds_read_b128 v[64:67], v252 offset:20480
    s_waitcnt lgkmcnt(9)
    v_mfma_f32_32x32x16_bf16 v[16:31], v[72:75], v[196:199], v[16:31]
    ds_read_b128 v[68:71], v252 offset:21504
    v_mfma_f32_32x32x16_bf16 v[32:47], v[196:199], v[76:79], v[32:47]
    ds_read_b128 v[72:75], v252 offset:22528
    s_waitcnt lgkmcnt(3)
    v_dot2c_f32_bf16 v248, v208, v208
    v_dot2c_f32_bf16 v249, v209, v209
    v_dot2c_f32_bf16 v248, v210, v210
    v_dot2c_f32_bf16 v249, v211, v211
    v_dot2c_f32_bf16 v248, v212, v212
    v_dot2c_f32_bf16 v249, v213, v213
    v_dot2c_f32_bf16 v248, v214, v214
    v_dot2c_f32_bf16 v249, v215, v215
    v_dot2c_f32_bf16 v248, v216, v216
    v_dot2c_f32_bf16 v249, v217, v217
    v_dot2c_f32_bf16 v248, v218, v218
    v_dot2c_f32_bf16 v249, v219, v219
    v_dot2c_f32_bf16 v248, v220, v220
    v_dot2c_f32_bf16 v249, v221, v221
    v_dot2c_f32_bf16 v248, v222, v222
    v_dot2c_f32_bf16 v249, v223, v223
    v_mfma_f32_32x32x16_bf16 v[16:31], v[80:83], v[200:203], v[16:31]
    ds_read_b128 v[76:79], v252 offset:23552
    v_mfma_f32_32x32x16_bf16 v[32:47], v[200:203], v[84:87], v[32:47]
    s_barrier
    ds_read_b128 v[224:227], v244 offset:8192
    ds_read_b128 v[228:231], v245 offset:8192
    ds_read_b128 v[232:235], v246 offset:8192
    ds_read_b128 v[236:239], v247 offset:8192
    ds_read_b128 v[80:83], v252 offset:24576
    v_mfma_f32_32x32x16_bf16 v[16:31], v[88:91], v[204:207], v[16:31]
    ds_read_b128 v[84:87], v252 offset:25600
    v_mfma_f32_32x32x16_bf16 v[32:47], v[204:207], v[92:95], v[32:47]
    ds_read_b128 v[88:91], v252 offset:26624
    s_waitcnt lgkmcnt(3)
    v_dot2c_f32_bf16 v248, v224, v224
    v_dot2c_f32_bf16 v249, v225, v225
    v_dot2c_f32_bf16 v248, v226, v226
    v_dot2c_f32_bf16 v249, v227, v227
    v_dot2c_f32_bf16 v248, v228, v228
    v_dot2c_f32_bf16 v249, v229, v229
    v_dot2c_f32_bf16 v248, v230, v230
    v_dot2c_f32_bf16 v249, v231, v231
    v_dot2c_f32_bf16 v248, v232, v232
    v_dot2c_f32_bf16 v249, v233, v233
    v_dot2c_f32_bf16 v248, v234, v234
    v_dot2c_f32_bf16 v249, v235, v235
    v_dot2c_f32_bf16 v248, v236, v236
    v_dot2c_f32_bf16 v249, v237, v237
    v_dot2c_f32_bf16 v248, v238, v238
    v_dot2c_f32_bf16 v249, v239, v239
    v_mfma_f32_32x32x16_bf16 v[16:31], v[64:67], v[208:211], v[16:31]
    ds_read_b128 v[92:95], v252 offset:27648
    v_mfma_f32_32x32x16_bf16 v[16:31], v[68:71], v[212:215], v[16:31]
    ds_read_b128 v[64:67], v12 offset:49152
    v_mfma_f32_32x32x16_bf16 v[16:31], v[72:75], v[216:219], v[16:31]
    ds_read_b128 v[68:71], v12 offset:50176
    v_mfma_f32_32x32x16_bf16 v[16:31], v[76:79], v[220:223], v[16:31]
    ds_read_b128 v[72:75], v12 offset:51200
    s_waitcnt lgkmcnt(5)
    v_mfma_f32_32x32x16_bf16 v[16:31], v[80:83], v[224:227], v[16:31]
    ds_read_b128 v[76:79], v12 offset:52224
    v_add_f32 v9, v248, v249
    v_mov_b32 v98, 0
    v_mov_b32 v249, v9
    v_mfma_f32_32x32x16_bf16 v[16:31], v[84:87], v[228:231], v[16:31]
    ds_read_b128 v[80:83], v12 offset:53248
    v_mov_b32 v99, 0
    s_nop 0
    v_permlane32_swap_b32 v9, v249
    s_waitcnt lgkmcnt(5)
    v_mfma_f32_32x32x16_bf16 v[16:31], v[88:91], v[232:235], v[16:31]
    ds_read_b128 v[84:87], v12 offset:54272
    v_add_f32 v9, v9, v249
    v_mul_f32 v9, 0x3b124925, v9
    v_mfma_f32_32x32x16_bf16 v[16:31], v[92:95], v[236:239], v[16:31]
    ds_read_b128 v[88:91], v12 offset:55296
    s_waitcnt lgkmcnt(5)
    v_mfma_f32_32x32x16_bf16 v[32:47], v[208:211], v[64:67], v[32:47]
    ds_read_b128 v[92:95], v12 offset:56320
    v_mfma_f32_32x32x16_bf16 v[32:47], v[212:215], v[68:71], v[32:47]
    s_barrier
    ds_read_b128 v[64:67], v101 offset:0
    v_mul_f32 v3, 0xbb124925, v31
    v_mul_f32 v248, 0xbb124925, v31
    s_nop 0
    s_waitcnt lgkmcnt(5)
    v_mfma_f32_32x32x16_bf16 v[32:47], v[216:219], v[72:75], v[32:47]
    ds_read_b128 v[68:71], v101 offset:1024
    v_permlane32_swap_b32 v3, v248
    v_mov_b32 v3, v248
    v_fma_f32 v9, -v3, v3, v9
    v_mfma_f32_32x32x16_bf16 v[32:47], v[220:223], v[76:79], v[32:47]
    ds_read_b128 v[72:75], v7 offset:0
    v_max_f32 v9, 0, v9
    v_add_f32 v9, 0x3727c5ac, v9
    v_rsq_f32 v250, v9
    s_waitcnt lgkmcnt(5)
    v_mfma_f32_32x32x16_bf16 v[32:47], v[224:227], v[80:83], v[32:47]
    ds_read_b128 v[76:79], v7 offset:1024
    v_cvt_pk_bf16_f32 v96, v3, v3
    ds_write_b32 v10, v250
    v_and_b32 v9, 0xffff0000, v96
    v_mfma_f32_32x32x16_bf16 v[32:47], v[228:231], v[84:87], v[32:47]
    ds_read_b128 v[80:83], v7 offset:2048
    v_sub_f32 v9, v3, v9
    v_cvt_pk_bf16_f32 v97, v9, v9
    ds_read_b128 v[104:107], v11 offset:0
    s_waitcnt lgkmcnt(7)
    v_mfma_f32_32x32x16_bf16 v[32:47], v[232:235], v[88:91], v[32:47]
    ds_read_b128 v[84:87], v7 offset:3072
    ds_read_b128 v[108:111], v11 offset:32
    ds_read_b128 v[112:115], v11 offset:64
    ds_read_b128 v[116:119], v11 offset:96
    v_mfma_f32_32x32x16_bf16 v[32:47], v[236:239], v[92:95], v[32:47]
    ds_read_b128 v[88:91], v7 offset:4096
    s_waitcnt lgkmcnt(10)
    v_mfma_f32_32x32x16_bf16 v[16:31], v[64:67], v[96:99], v[16:31]
    ds_read_b128 v[92:95], v7 offset:5120
    v_mfma_f32_32x32x16_bf16 v[32:47], v[96:99], v[68:71], v[32:47]
    ds_read_b128 v[64:67], v7 offset:6144
    s_waitcnt lgkmcnt(10)
    v_mfma_f32_32x32x16_bf16 v[48:63], v[72:75], v[128:131], 0
    ds_read_b128 v[68:71], v7 offset:7168
    v_mul_f32 v16, v16, v250
    v_mul_f32 v17, v17, v250
    v_mul_f32 v18, v18, v250
    v_mul_f32 v19, v19, v250
    v_mfma_f32_32x32x16_bf16 v[48:63], v[76:79], v[132:135], v[48:63]
    ds_read_b128 v[72:75], v7 offset:8192
    v_mul_f32 v20, v20, v250
    v_mul_f32 v21, v21, v250
    v_mul_f32 v22, v22, v250
    v_mul_f32 v23, v23, v250
    s_waitcnt lgkmcnt(8)
    v_mfma_f32_32x32x16_bf16 v[48:63], v[80:83], v[136:139], v[48:63]
    ds_read_b128 v[76:79], v7 offset:9216
    v_cvt_pk_bf16_f32 v120, v16, v17
    v_cvt_pk_bf16_f32 v121, v18, v19
    v_cvt_pk_bf16_f32 v122, v20, v21
    v_cvt_pk_bf16_f32 v123, v22, v23
    v_mfma_f32_32x32x16_bf16 v[48:63], v[84:87], v[140:143], v[48:63]
    ds_read_b128 v[80:83], v7 offset:10240
    buffer_store_dwordx4 v[120:123], v253, s[12:15], s30 offen offset:0
    v_mul_f32 v24, v24, v250
    v_mul_f32 v25, v25, v250
    s_waitcnt lgkmcnt(5)
    v_mfma_f32_32x32x16_bf16 v[48:63], v[88:91], v[144:147], v[48:63]
    ds_read_b128 v[84:87], v7 offset:11264
    v_mul_f32 v26, v26, v250
    v_mul_f32 v27, v27, v250
    v_mul_f32 v28, v28, v250
    v_mul_f32 v29, v29, v250
    v_mfma_f32_32x32x16_bf16 v[48:63], v[92:95], v[148:151], v[48:63]
    ds_read_b128 v[88:91], v7 offset:12288
    v_mul_f32 v30, v30, v250
    v_mul_f32 v31, v31, v250
    v_cvt_pk_bf16_f32 v124, v24, v25
    v_cvt_pk_bf16_f32 v125, v26, v27
    s_waitcnt lgkmcnt(5)
    v_mfma_f32_32x32x16_bf16 v[48:63], v[64:67], v[152:155], v[48:63]
    ds_read_b128 v[92:95], v7 offset:13312
    v_cvt_pk_bf16_f32 v126, v28, v29
    v_cvt_pk_bf16_f32 v127, v30, v31
    v_cndmask_b32 v126, v126, v254, s[64:65]
    v_cndmask_b32 v127, v127, v255, s[64:65]
    v_mfma_f32_32x32x16_bf16 v[48:63], v[68:71], v[156:159], v[48:63]
    ds_read_b128 v[64:67], v7 offset:14336
    buffer_store_dwordx4 v[124:127], v253, s[12:15], s30 offen offset:1024
    v_mul_f32 v32, v32, v104
    s_waitcnt lgkmcnt(5)
    v_mfma_f32_32x32x16_bf16 v[48:63], v[72:75], v[160:163], v[48:63]
    ds_read_b128 v[68:71], v7 offset:15360
    v_mul_f32 v33, v33, v105
    v_mul_f32 v34, v34, v106
    v_mul_f32 v35, v35, v107
    v_mul_f32 v36, v36, v108
    v_mfma_f32_32x32x16_bf16 v[48:63], v[76:79], v[164:167], v[48:63]
    ds_read_b128 v[72:75], v7 offset:16384
    v_mul_f32 v37, v37, v109
    v_mul_f32 v38, v38, v110
    v_mul_f32 v39, v39, v111
    v_cvt_pk_bf16_f32 v104, v32, v33
    s_waitcnt lgkmcnt(5)
    v_mfma_f32_32x32x16_bf16 v[48:63], v[80:83], v[168:171], v[48:63]
    ds_read_b128 v[76:79], v7 offset:17408
    v_cvt_pk_bf16_f32 v105, v34, v35
    v_cvt_pk_bf16_f32 v106, v36, v37
    v_cvt_pk_bf16_f32 v107, v38, v39
    v_cndmask_b32 v104, v104, v251, s[66:67]
    v_mfma_f32_32x32x16_bf16 v[48:63], v[84:87], v[172:175], v[48:63]
    ds_read_b128 v[80:83], v7 offset:18432
    v_cndmask_b32 v105, v105, v251, s[66:67]
    v_cndmask_b32 v106, v106, v251, s[66:67]
    v_cndmask_b32 v107, v107, v251, s[66:67]
    buffer_store_dwordx4 v[104:107], v1, s[12:15], s30 offen offset:2048
    s_waitcnt lgkmcnt(5)
    v_mfma_f32_32x32x16_bf16 v[48:63], v[88:91], v[176:179], v[48:63]
    ds_read_b128 v[84:87], v7 offset:19456
    v_mul_f32 v40, v40, v112
    v_mul_f32 v41, v41, v113
    v_mul_f32 v42, v42, v114
    v_mfma_f32_32x32x16_bf16 v[48:63], v[92:95], v[180:183], v[48:63]
    ds_read_b128 v[88:91], v7 offset:20480
    v_mul_f32 v43, v43, v115
    v_mul_f32 v44, v44, v116
    v_mul_f32 v45, v45, v117
    v_mul_f32 v46, v46, v118
    s_waitcnt lgkmcnt(5)
    v_mfma_f32_32x32x16_bf16 v[48:63], v[64:67], v[184:187], v[48:63]
    ds_read_b128 v[92:95], v7 offset:21504
    v_mul_f32 v47, v47, v119
    v_cvt_pk_bf16_f32 v112, v40, v41
    v_cvt_pk_bf16_f32 v113, v42, v43
    v_cvt_pk_bf16_f32 v114, v44, v45
    v_mfma_f32_32x32x16_bf16 v[48:63], v[68:71], v[188:191], v[48:63]
    ds_read_b128 v[64:67], v7 offset:22528
    v_cvt_pk_bf16_f32 v115, v46, v47
    v_cndmask_b32 v112, v112, v251, s[66:67]
    v_cndmask_b32 v113, v113, v251, s[66:67]
    v_cndmask_b32 v114, v114, v251, s[66:67]
    s_waitcnt lgkmcnt(5)
    v_mfma_f32_32x32x16_bf16 v[48:63], v[72:75], v[192:195], v[48:63]
    ds_read_b128 v[68:71], v7 offset:23552
    v_cndmask_b32 v115, v115, v251, s[66:67]
    buffer_store_dwordx4 v[112:115], v1, s[12:15], s30 offen offset:3072
    v_mfma_f32_32x32x16_bf16 v[48:63], v[76:79], v[196:199], v[48:63]
    ds_read_b128 v[72:75], v7 offset:24576
    ds_write_b128 v4, v[120:123] offset:0
    s_waitcnt lgkmcnt(6)
    v_mfma_f32_32x32x16_bf16 v[48:63], v[80:83], v[200:203], v[48:63]
    ds_read_b128 v[76:79], v7 offset:25600
    v_mov_b32 v16, 0
    v_mov_b32 v17, 0
    v_mov_b32 v18, 0
    v_mov_b32 v19, 0
    v_mov_b32 v9, s25
    s_cmp_lg_u32 s26, 0
    s_waitcnt vmcnt(0)
    buffer_store_dword v9, v2, s[12:15], s31 offen
    s_cbranch_scc1 Lpubg_1
Lpubd_2:
    v_mfma_f32_32x32x16_bf16 v[48:63], v[84:87], v[204:207], v[48:63]
    ds_read_b128 v[80:83], v7 offset:26624
    ds_write_b128 v4, v[124:127] offset:1024
    s_waitcnt lgkmcnt(7)
    v_mfma_f32_32x32x16_bf16 v[48:63], v[88:91], v[208:211], v[48:63]
    ds_read_b128 v[84:87], v7 offset:27648
    v_mov_b32 v20, 0
    v_mov_b32 v21, 0
    v_mov_b32 v22, 0
    v_mov_b32 v23, 0
    v_mfma_f32_32x32x16_bf16 v[48:63], v[92:95], v[212:215], v[48:63]
    s_barrier
    ds_read_b128 v[88:91], v101 offset:2048
    ds_write_b128 v5, v[104:107] offset:2048
    s_waitcnt lgkmcnt(8)
    v_mfma_f32_32x32x16_bf16 v[48:63], v[64:67], v[216:219], v[48:63]
    v_mov_b32 v24, 0
    v_mov_b32 v25, 0
    v_mov_b32 v26, 0
    v_mov_b32 v27, 0
    v_mfma_f32_32x32x16_bf16 v[48:63], v[68:71], v[220:223], v[48:63]
    ds_write_b128 v5, v[112:115] offset:3072
    s_waitcnt lgkmcnt(6)
    v_mfma_f32_32x32x16_bf16 v[48:63], v[72:75], v[224:227], v[48:63]
    v_mov_b32 v28, 0
    v_mov_b32 v29, 0
    v_mov_b32 v30, 0
    v_mov_b32 v31, 0
    v_mfma_f32_32x32x16_bf16 v[48:63], v[76:79], v[228:231], v[48:63]
    v_mul_f32 v250, 0x3e8b97f6, v250
    s_waitcnt lgkmcnt(3)
    v_mfma_f32_32x32x16_bf16 v[48:63], v[80:83], v[232:235], v[48:63]
    v_mfma_f32_32x32x16_bf16 v[48:63], v[84:87], v[236:239], v[48:63]
    s_waitcnt lgkmcnt(2)
    v_mfma_f32_32x32x16_bf16 v[48:63], v[88:91], v[96:99], v[48:63]
    v_mov_b32 v9, 0
    v_mov_b32 v10, 0
    s_nop 9
    v_mul_f32 v48, v48, v250
    v_mul_f32 v49, v49, v250
    v_mul_f32 v50, v50, v250
    v_mul_f32 v51, v51, v250
    v_mul_f32 v52, v52, v250
    v_mul_f32 v53, v53, v250
    v_mul_f32 v54, v54, v250
    v_mul_f32 v55, v55, v250
    v_cvt_pk_bf16_f32 v80, v48, v49
    v_cvt_pk_bf16_f32 v81, v50, v51
    v_cvt_pk_bf16_f32 v82, v52, v53
    v_cvt_pk_bf16_f32 v83, v54, v55
    ds_write_b128 v6, v[80:83]
    v_mul_f32 v56, v56, v250
    v_mul_f32 v57, v57, v250
    v_mul_f32 v58, v58, v250
    v_mul_f32 v59, v59, v250
    v_mul_f32 v60, v60, v250
    v_mul_f32 v61, v61, v250
    v_mul_f32 v62, v62, v250
    v_mul_f32 v63, v63, v250
    v_cvt_pk_bf16_f32 v84, v56, v57
    v_cvt_pk_bf16_f32 v85, v58, v59
    v_cvt_pk_bf16_f32 v86, v60, v61
    v_cvt_pk_bf16_f32 v87, v62, v63
    v_cndmask_b32 v86, v86, 0, s[64:65]
    v_cndmask_b32 v87, v87, 0, s[64:65]
    v_dot2c_f32_bf16 v9, v80, v120
    v_dot2c_f32_bf16 v9, v81, v121
    v_dot2c_f32_bf16 v9, v82, v122
    v_dot2c_f32_bf16 v9, v83, v123
    v_dot2c_f32_bf16 v9, v84, v124
    v_dot2c_f32_bf16 v9, v85, v125
    v_dot2c_f32_bf16 v9, v86, v126
    v_dot2c_f32_bf16 v9, v87, v127
    s_nop 2
    v_permlane32_swap_b32 v10, v9
    v_add_f32 v9, v9, v10
    v_cvt_pk_bf16_f32 v9, -v9, 0
    v_cndmask_b32 v86, v86, v9, s[64:65]
    ds_write_b128 v6, v[84:87] offset:1024
    v_add_u32 v4, 0, v1
    v_add_u32 v5, 65536, v1
    v_add_u32 v6, 131072, v1
    v_mov_b32 v7, 0xdddddddd
    v_add_u32 v96, s69, v1
    v_mov_b32 v13, s24
    s_waitcnt lgkmcnt(0)
    s_barrier
    ds_read_b128 v[64:67], v4 offset:0
    ds_read_b128 v[68:71], v4 offset:1024
    s_setprio 2
    s_waitcnt lgkmcnt(1)
    v_mfma_f32_32x32x16_bf16 v[32:47], v[64:67], v[80:83], 0
    ds_read_b128 v[64:67], v4 offset:4096
    s_add_u32 m0, s71, 98304
    s_add_u32 s54, s54, 49152
    s_and_b32 s54, s54, 245760
    buffer_load_dwordx4 v96, s[12:15], s54 offen offset:0 sc1 lds
    s_waitcnt lgkmcnt(1)
    v_mfma_f32_32x32x16_bf16 v[32:47], v[68:71], v[84:87], v[32:47]
    ds_read_b128 v[68:71], v4 offset:5120
    buffer_load_dwordx4 v96, s[12:15], s54 offen offset:1024 sc1 lds
    ds_read_b128 v[72:75], v4 offset:2048
    ds_read_b128 v[76:79], v4 offset:3072
    s_setprio 0
    s_nop 6
    v_exp_f32 v32, v32
    v_exp_f32 v33, v33
    v_exp_f32 v34, v34
    v_exp_f32 v35, v35
    v_exp_f32 v36, v36
    v_exp_f32 v37, v37
    v_exp_f32 v38, v38
    v_exp_f32 v39, v39
    s_setprio 1
    v_exp_f32 v40, v40
    v_exp_f32 v41, v41
    v_exp_f32 v42, v42
    v_exp_f32 v43, v43
    v_exp_f32 v44, v44
    v_exp_f32 v45, v45
    v_exp_f32 v46, v46
    v_exp_f32 v47, v47
    s_setprio 2
    s_waitcnt lgkmcnt(3)
    v_mfma_f32_32x32x16_bf16 v[48:63], v[64:67], v[80:83], 0
    s_add_u32 m0, s71, 114688
    s_add_u32 s54, s54, 16384
    s_and_b32 s54, s54, 245760
    buffer_load_dwordx4 v96, s[12:15], s54 offen offset:0 sc1 lds
    s_waitcnt lgkmcnt(2)
    v_mfma_f32_32x32x16_bf16 v[48:63], v[68:71], v[84:87], v[48:63]
    buffer_load_dwordx4 v96, s[12:15], s54 offen offset:1024 sc1 lds
    s_waitcnt lgkmcnt(1)
    v_smfmac_f32_32x32x32_bf16 v[16:31], v[72:75], v[32:39], v7
    ds_read_b128 v[72:75], v4 offset:6144
    s_waitcnt lgkmcnt(1)
    v_smfmac_f32_32x32x32_bf16 v[16:31], v[76:79], v[40:47], v7
    ds_read_b128 v[76:79], v4 offset:7168
    s_setprio 0
    v_exp_f32 v48, v48
    v_exp_f32 v49, v49
    v_exp_f32 v50, v50
    v_exp_f32 v51, v51
    v_exp_f32 v52, v52
    v_exp_f32 v53, v53
    v_exp_f32 v54, v54
    v_exp_f32 v55, v55
    s_setprio 1
    v_exp_f32 v56, v56
    v_exp_f32 v57, v57
    v_exp_f32 v58, v58
    v_exp_f32 v59, v59
    v_exp_f32 v60, v60
    v_exp_f32 v61, v61
    v_exp_f32 v62, v62
    v_exp_f32 v63, v63
    s_barrier
    ds_read_b128 v[64:67], v5 offset:0
    ds_read_b128 v[68:71], v5 offset:1024
    s_setprio 2
    s_waitcnt lgkmcnt(3)
    v_smfmac_f32_32x32x32_bf16 v[16:31], v[72:75], v[48:55], v7
    ds_read_b128 v[72:75], v5 offset:2048
    buffer_load_ushort v97, v242, s[16:19], s81 offen
    s_waitcnt lgkmcnt(2)
    v_mfma_f32_32x32x16_bf16 v[32:47], v[64:67], v[80:83], 0
    ds_read_b128 v[64:67], v5 offset:4096
    buffer_load_dword v104, v1, s[20:23], 0 offen
    s_waitcnt lgkmcnt(2)
    v_mfma_f32_32x32x16_bf16 v[32:47], v[68:71], v[84:87], v[32:47]
    ds_read_b128 v[68:71], v5 offset:5120
    buffer_load_dwordx4 v96, s[12:15], s54 offen offset:2048 sc1 lds
    v_smfmac_f32_32x32x32_bf16 v[16:31], v[76:79], v[56:63], v7
    ds_read_b128 v[76:79], v5 offset:3072
    buffer_load_dwordx4 v96, s[12:15], s54 offen offset:3072 sc1 lds
    s_setprio 0
    s_nop 1
    v_exp_f32 v32, v32
    v_exp_f32 v33, v33
    v_exp_f32 v34, v34
    v_exp_f32 v35, v35
    v_exp_f32 v36, v36
    v_exp_f32 v37, v37
    v_exp_f32 v38, v38
    v_exp_f32 v39, v39
    s_setprio 1
    v_exp_f32 v40, v40
    v_exp_f32 v41, v41
    v_exp_f32 v42, v42
    v_exp_f32 v43, v43
    v_exp_f32 v44, v44
    v_exp_f32 v45, v45
    v_exp_f32 v46, v46
    v_exp_f32 v47, v47
    s_setprio 2
    s_waitcnt lgkmcnt(2)
    v_mfma_f32_32x32x16_bf16 v[48:63], v[64:67], v[80:83], 0
    ds_read_b128 v[64:67], v5 offset:16384
    buffer_load_dwordx4 v[88:91], v240, s[8:11], s79 offen
    s_waitcnt lgkmcnt(2)
    v_mfma_f32_32x32x16_bf16 v[48:63], v[68:71], v[84:87], v[48:63]
    ds_read_b128 v[68:71], v5 offset:17408
    s_add_u32 m0, s71, 131072
    s_add_u32 s54, s54, 16384
    s_and_b32 s54, s54, 245760
    buffer_load_dwordx4 v96, s[12:15], s54 offen offset:0 sc1 lds
    v_smfmac_f32_32x32x32_bf16 v[16:31], v[72:75], v[32:39], v7
    ds_read_b128 v[72:75], v5 offset:6144
    s_waitcnt lgkmcnt(3)
    v_smfmac_f32_32x32x32_bf16 v[16:31], v[76:79], v[40:47], v7
    ds_read_b128 v[76:79], v5 offset:7168
    s_setprio 0
    v_exp_f32 v48, v48
    v_exp_f32 v49, v49
    v_exp_f32 v50, v50
    v_exp_f32 v51, v51
    v_exp_f32 v52, v52
    v_exp_f32 v53, v53
    v_exp_f32 v54, v54
    v_exp_f32 v55, v55
    s_setprio 1
    v_exp_f32 v56, v56
    v_exp_f32 v57, v57
    v_exp_f32 v58, v58
    v_exp_f32 v59, v59
    v_exp_f32 v60, v60
    v_exp_f32 v61, v61
    v_exp_f32 v62, v62
    v_exp_f32 v63, v63
    s_setprio 2
    s_waitcnt lgkmcnt(3)
    v_mfma_f32_32x32x16_bf16 v[32:47], v[64:67], v[80:83], 0
    ds_read_b128 v[64:67], v5 offset:20480
    buffer_load_dwordx4 v[92:95], v241, s[8:11], s79 offen
    s_waitcnt lgkmcnt(3)
    v_mfma_f32_32x32x16_bf16 v[32:47], v[68:71], v[84:87], v[32:47]
    ds_read_b128 v[68:71], v5 offset:21504
    buffer_load_dwordx4 v96, s[12:15], s54 offen offset:1024 sc1 lds
    s_waitcnt lgkmcnt(3)
    v_smfmac_f32_32x32x32_bf16 v[16:31], v[72:75], v[48:55], v7
    ds_read_b128 v[72:75], v5 offset:18432
    s_waitcnt lgkmcnt(3)
    v_smfmac_f32_32x32x32_bf16 v[16:31], v[76:79], v[56:63], v7
    ds_read_b128 v[76:79], v5 offset:19456
    s_setprio 0
    v_exp_f32 v32, v32
    v_exp_f32 v33, v33
    v_exp_f32 v34, v34
    v_exp_f32 v35, v35
    v_exp_f32 v36, v36
    v_exp_f32 v37, v37
    v_exp_f32 v38, v38
    v_exp_f32 v39, v39
    s_setprio 1
    v_exp_f32 v40, v40
    v_exp_f32 v41, v41
    v_exp_f32 v42, v42
    v_exp_f32 v43, v43
    v_exp_f32 v44, v44
    v_exp_f32 v45, v45
    v_exp_f32 v46, v46
    v_exp_f32 v47, v47
    s_waitcnt vmcnt(10)
    s_barrier
    s_setprio 2
    s_waitcnt lgkmcnt(3)
    v_mfma_f32_32x32x16_bf16 v[48:63], v[64:67], v[80:83], 0
    ds_read_b128 v[64:67], v5 offset:32768
    s_add_u32 m0, s71, 147456
    s_add_u32 s54, s54, 16384
    s_and_b32 s54, s54, 245760
    buffer_load_dwordx4 v96, s[12:15], s54 offen offset:0 sc1 lds
    s_waitcnt lgkmcnt(3)
    v_mfma_f32_32x32x16_bf16 v[48:63], v[68:71], v[84:87], v[48:63]
    ds_read_b128 v[68:71], v5 offset:33792
    buffer_load_dwordx4 v96, s[12:15], s54 offen offset:1024 sc1 lds
    s_waitcnt lgkmcnt(3)
    v_smfmac_f32_32x32x32_bf16 v[16:31], v[72:75], v[32:39], v7
    ds_read_b128 v[72:75], v5 offset:22528
    s_waitcnt lgkmcnt(3)
    v_smfmac_f32_32x32x32_bf16 v[16:31], v[76:79], v[40:47], v7
    ds_read_b128 v[76:79], v5 offset:23552
    s_setprio 0
    v_exp_f32 v48, v48
    v_exp_f32 v49, v49
    v_exp_f32 v50, v50
    v_exp_f32 v51, v51
    v_exp_f32 v52, v52
    v_exp_f32 v53, v53
    v_exp_f32 v54, v54
    v_exp_f32 v55, v55
    s_setprio 1
    v_exp_f32 v56, v56
    v_exp_f32 v57, v57
    v_exp_f32 v58, v58
    v_exp_f32 v59, v59
    v_exp_f32 v60, v60
    v_exp_f32 v61, v61
    v_exp_f32 v62, v62
    v_exp_f32 v63, v63
    s_setprio 2
    s_waitcnt lgkmcnt(3)
    v_mfma_f32_32x32x16_bf16 v[32:47], v[64:67], v[80:83], 0
    ds_read_b128 v[64:67], v5 offset:36864
    buffer_load_dwordx4 v96, s[12:15], s54 offen offset:2048 sc1 lds
    s_waitcnt lgkmcnt(3)
    v_mfma_f32_32x32x16_bf16 v[32:47], v[68:71], v[84:87], v[32:47]
    ds_read_b128 v[68:71], v5 offset:37888
    buffer_load_dwordx4 v96, s[12:15], s54 offen offset:3072 sc1 lds
    s_waitcnt lgkmcnt(3)
    v_smfmac_f32_32x32x32_bf16 v[16:31], v[72:75], v[48:55], v7
    ds_read_b128 v[72:75], v5 offset:34816
    s_waitcnt lgkmcnt(3)
    v_smfmac_f32_32x32x32_bf16 v[16:31], v[76:79], v[56:63], v7
    ds_read_b128 v[76:79], v5 offset:35840
    s_setprio 0
    v_exp_f32 v32, v32
    v_exp_f32 v33, v33
    v_exp_f32 v34, v34
    v_exp_f32 v35, v35
    v_exp_f32 v36, v36
    v_exp_f32 v37, v37
    v_exp_f32 v38, v38
    v_exp_f32 v39, v39
    s_setprio 1
    v_exp_f32 v40, v40
    v_exp_f32 v41, v41
    v_exp_f32 v42, v42
    v_exp_f32 v43, v43
    v_exp_f32 v44, v44
    v_exp_f32 v45, v45
    v_exp_f32 v46, v46
    v_exp_f32 v47, v47
    s_waitcnt vmcnt(8)
    s_barrier
    s_setprio 2
    s_waitcnt lgkmcnt(3)
    v_mfma_f32_32x32x16_bf16 v[48:63], v[64:67], v[80:83], 0
    ds_read_b128 v[64:67], v5 offset:49152
    s_add_u32 m0, s71, 81920
    s_add_u32 s54, s54, 16384
    s_and_b32 s54, s54, 245760
    buffer_load_dwordx4 v96, s[12:15], s54 offen offset:0 sc1 lds
    s_waitcnt lgkmcnt(3)
    v_mfma_f32_32x32x16_bf16 v[48:63], v[68:71], v[84:87], v[48:63]
    ds_read_b128 v[68:71], v5 offset:50176
    buffer_load_dwordx4 v96, s[12:15], s54 offen offset:1024 sc1 lds
    s_waitcnt lgkmcnt(3)
    v_smfmac_f32_32x32x32_bf16 v[16:31], v[72:75], v[32:39], v7
    ds_read_b128 v[72:75], v5 offset:38912
    s_waitcnt lgkmcnt(3)
    v_smfmac_f32_32x32x32_bf16 v[16:31], v[76:79], v[40:47], v7
    ds_read_b128 v[76:79], v5 offset:39936
    s_setprio 0
    v_exp_f32 v48, v48
    v_exp_f32 v49, v49
    v_exp_f32 v50, v50
    v_exp_f32 v51, v51
    v_exp_f32 v52, v52
    v_exp_f32 v53, v53
    v_exp_f32 v54, v54
    v_exp_f32 v55, v55
    s_setprio 1
    v_exp_f32 v56, v56
    v_exp_f32 v57, v57
    v_exp_f32 v58, v58
    v_exp_f32 v59, v59
    v_exp_f32 v60, v60
    v_exp_f32 v61, v61
    v_exp_f32 v62, v62
    v_exp_f32 v63, v63
    s_setprio 2
    s_waitcnt lgkmcnt(3)
    v_mfma_f32_32x32x16_bf16 v[32:47], v[64:67], v[80:83], 0
    ds_read_b128 v[64:67], v5 offset:53248
    buffer_load_dwordx4 v96, s[12:15], s54 offen offset:2048 sc1 lds
    s_waitcnt lgkmcnt(3)
    v_mfma_f32_32x32x16_bf16 v[32:47], v[68:71], v[84:87], v[32:47]
    ds_read_b128 v[68:71], v5 offset:54272
    buffer_load_dwordx4 v96, s[12:15], s54 offen offset:3072 sc1 lds
    s_waitcnt lgkmcnt(3)
    v_smfmac_f32_32x32x32_bf16 v[16:31], v[72:75], v[48:55], v7
    ds_read_b128 v[72:75], v5 offset:51200
    s_waitcnt lgkmcnt(3)
    v_smfmac_f32_32x32x32_bf16 v[16:31], v[76:79], v[56:63], v7
    ds_read_b128 v[76:79], v5 offset:52224
    s_setprio 0
    v_exp_f32 v32, v32
    v_exp_f32 v33, v33
    v_exp_f32 v34, v34
    v_exp_f32 v35, v35
    v_exp_f32 v36, v36
    v_exp_f32 v37, v37
    v_exp_f32 v38, v38
    v_exp_f32 v39, v39
    s_setprio 1
    v_exp_f32 v40, v40
    v_exp_f32 v41, v41
    v_exp_f32 v42, v42
    v_exp_f32 v43, v43
    v_exp_f32 v44, v44
    v_exp_f32 v45, v45
    v_exp_f32 v46, v46
    v_exp_f32 v47, v47
    s_waitcnt vmcnt(8)
    s_barrier
    s_setprio 2
    s_waitcnt lgkmcnt(3)
    v_mfma_f32_32x32x16_bf16 v[48:63], v[64:67], v[80:83], 0
    ds_read_b128 v[64:67], v6 offset:0
    buffer_store_dword v13, v2, s[12:15], s78 offen sc1
    s_waitcnt lgkmcnt(3)
    v_mfma_f32_32x32x16_bf16 v[48:63], v[68:71], v[84:87], v[48:63]
    ds_read_b128 v[68:71], v6 offset:1024
    s_add_u32 m0, s71, 98304
    s_add_u32 s54, s54, 16384
    s_and_b32 s54, s54, 245760
    buffer_load_dwordx4 v96, s[12:15], s54 offen offset:0 sc1 lds
    s_waitcnt lgkmcnt(3)
    v_smfmac_f32_32x32x32_bf16 v[16:31], v[72:75], v[32:39], v7
    ds_read_b128 v[72:75], v5 offset:55296
    buffer_load_dwordx4 v96, s[12:15], s54 offen offset:1024 sc1 lds
    s_waitcnt lgkmcnt(3)
    v_smfmac_f32_32x32x32_bf16 v[16:31], v[76:79], v[40:47], v7
    ds_read_b128 v[76:79], v5 offset:56320
    s_setprio 0
    v_exp_f32 v48, v48
    v_exp_f32 v49, v49
    v_exp_f32 v50, v50
    v_exp_f32 v51, v51
    v_exp_f32 v52, v52
    v_exp_f32 v53, v53
    v_exp_f32 v54, v54
    v_exp_f32 v55, v55
    s_setprio 1
    v_exp_f32 v56, v56
    v_exp_f32 v57, v57
    v_exp_f32 v58, v58
    v_exp_f32 v59, v59
    v_exp_f32 v60, v60
    v_exp_f32 v61, v61
    v_exp_f32 v62, v62
    v_exp_f32 v63, v63
    s_setprio 2
    s_waitcnt lgkmcnt(3)
    v_mfma_f32_32x32x16_bf16 v[32:47], v[64:67], v[80:83], 0
    ds_read_b128 v[64:67], v6 offset:4096
    buffer_load_dwordx4 v96, s[12:15], s54 offen offset:2048 sc1 lds
    s_waitcnt lgkmcnt(3)
    v_mfma_f32_32x32x16_bf16 v[32:47], v[68:71], v[84:87], v[32:47]
    ds_read_b128 v[68:71], v6 offset:5120
    buffer_load_dwordx4 v96, s[12:15], s54 offen offset:3072 sc1 lds
    s_waitcnt lgkmcnt(3)
    v_smfmac_f32_32x32x32_bf16 v[16:31], v[72:75], v[48:55], v7
    ds_read_b128 v[72:75], v6 offset:2048
    s_waitcnt lgkmcnt(3)
    v_smfmac_f32_32x32x32_bf16 v[16:31], v[76:79], v[56:63], v7
    ds_read_b128 v[76:79], v6 offset:3072
    s_setprio 0
    v_exp_f32 v32, v32
    v_exp_f32 v33, v33
    v_exp_f32 v34, v34
    v_exp_f32 v35, v35
    v_exp_f32 v36, v36
    v_exp_f32 v37, v37
    v_exp_f32 v38, v38
    v_exp_f32 v39, v39
    s_setprio 1
    v_exp_f32 v40, v40
    v_exp_f32 v41, v41
    v_exp_f32 v42, v42
    v_exp_f32 v43, v43
    v_exp_f32 v44, v44
    v_exp_f32 v45, v45
    v_exp_f32 v46, v46
    v_exp_f32 v47, v47
    s_waitcnt vmcnt(9)
    s_barrier
    s_setprio 2
    s_waitcnt lgkmcnt(3)
    v_mfma_f32_32x32x16_bf16 v[48:63], v[64:67], v[80:83], 0
    ds_read_b128 v[64:67], v6 offset:16384
    s_add_u32 m0, s71, 114688
    s_add_u32 s54, s54, 16384
    s_and_b32 s54, s54, 245760
    buffer_load_dwordx4 v96, s[12:15], s54 offen offset:0 sc1 lds
    s_waitcnt lgkmcnt(3)
    v_mfma_f32_32x32x16_bf16 v[48:63], v[68:71], v[84:87], v[48:63]
    ds_read_b128 v[68:71], v6 offset:17408
    buffer_load_dwordx4 v96, s[12:15], s54 offen offset:1024 sc1 lds
    s_waitcnt lgkmcnt(3)
    v_smfmac_f32_32x32x32_bf16 v[16:31], v[72:75], v[32:39], v7
    ds_read_b128 v[72:75], v6 offset:6144
    s_waitcnt lgkmcnt(3)
    v_smfmac_f32_32x32x32_bf16 v[16:31], v[76:79], v[40:47], v7
    ds_read_b128 v[76:79], v6 offset:7168
    s_setprio 0
    v_exp_f32 v48, v48
    v_exp_f32 v49, v49
    v_exp_f32 v50, v50
    v_exp_f32 v51, v51
    v_exp_f32 v52, v52
    v_exp_f32 v53, v53
    v_exp_f32 v54, v54
    v_exp_f32 v55, v55
    s_setprio 1
    v_exp_f32 v56, v56
    v_exp_f32 v57, v57
    v_exp_f32 v58, v58
    v_exp_f32 v59, v59
    v_exp_f32 v60, v60
    v_exp_f32 v61, v61
    v_exp_f32 v62, v62
    v_exp_f32 v63, v63
    s_setprio 2
    s_waitcnt lgkmcnt(3)
    v_mfma_f32_32x32x16_bf16 v[32:47], v[64:67], v[80:83], 0
    ds_read_b128 v[64:67], v6 offset:20480
    buffer_load_dwordx4 v96, s[12:15], s54 offen offset:2048 sc1 lds
    s_waitcnt lgkmcnt(3)
    v_mfma_f32_32x32x16_bf16 v[32:47], v[68:71], v[84:87], v[32:47]
    ds_read_b128 v[68:71], v6 offset:21504
    buffer_load_dwordx4 v96, s[12:15], s54 offen offset:3072 sc1 lds
    s_waitcnt lgkmcnt(3)
    v_smfmac_f32_32x32x32_bf16 v[16:31], v[72:75], v[48:55], v7
    ds_read_b128 v[72:75], v6 offset:18432
    s_waitcnt lgkmcnt(3)
    v_smfmac_f32_32x32x32_bf16 v[16:31], v[76:79], v[56:63], v7
    ds_read_b128 v[76:79], v6 offset:19456
    s_setprio 0
    v_exp_f32 v32, v32
    v_exp_f32 v33, v33
    v_exp_f32 v34, v34
    v_exp_f32 v35, v35
    v_exp_f32 v36, v36
    v_exp_f32 v37, v37
    v_exp_f32 v38, v38
    v_exp_f32 v39, v39
    s_setprio 1
    v_exp_f32 v40, v40
    v_exp_f32 v41, v41
    v_exp_f32 v42, v42
    v_exp_f32 v43, v43
    v_exp_f32 v44, v44
    v_exp_f32 v45, v45
    v_exp_f32 v46, v46
    v_exp_f32 v47, v47
    s_waitcnt vmcnt(9)
    s_barrier
    s_setprio 2
    s_waitcnt lgkmcnt(3)
    v_mfma_f32_32x32x16_bf16 v[48:63], v[64:67], v[80:83], 0
    ds_read_b128 v[64:67], v5 offset:16384
    s_add_u32 m0, s71, 131072
    s_add_u32 s54, s54, 16384
    s_and_b32 s54, s54, 245760
    buffer_load_dwordx4 v96, s[12:15], s54 offen offset:0 sc1 lds
    s_waitcnt lgkmcnt(3)
    v_mfma_f32_32x32x16_bf16 v[48:63], v[68:71], v[84:87], v[48:63]
    ds_read_b128 v[68:71], v5 offset:17408
    buffer_load_dwordx4 v96, s[12:15], s54 offen offset:1024 sc1 lds
    s_waitcnt lgkmcnt(3)
    v_smfmac_f32_32x32x32_bf16 v[16:31], v[72:75], v[32:39], v7
    ds_read_b128 v[72:75], v6 offset:22528
    s_waitcnt lgkmcnt(3)
    v_smfmac_f32_32x32x32_bf16 v[16:31], v[76:79], v[40:47], v7
    ds_read_b128 v[76:79], v6 offset:23552
    s_setprio 0
    v_exp_f32 v48, v48
    v_exp_f32 v49, v49
    v_exp_f32 v50, v50
    v_exp_f32 v51, v51
    v_exp_f32 v52, v52
    v_exp_f32 v53, v53
    v_exp_f32 v54, v54
    v_exp_f32 v55, v55
    s_setprio 1
    v_exp_f32 v56, v56
    v_exp_f32 v57, v57
    v_exp_f32 v58, v58
    v_exp_f32 v59, v59
    v_exp_f32 v60, v60
    v_exp_f32 v61, v61
    v_exp_f32 v62, v62
    v_exp_f32 v63, v63
    s_setprio 2
    s_waitcnt lgkmcnt(3)
    v_mfma_f32_32x32x16_bf16 v[32:47], v[64:67], v[80:83], 0
    ds_read_b128 v[64:67], v5 offset:20480
    buffer_load_dwordx4 v96, s[12:15], s54 offen offset:2048 sc1 lds
    s_waitcnt lgkmcnt(3)
    v_mfma_f32_32x32x16_bf16 v[32:47], v[68:71], v[84:87], v[32:47]
    ds_read_b128 v[68:71], v5 offset:21504
    buffer_load_dwordx4 v96, s[12:15], s54 offen offset:3072 sc1 lds
    s_waitcnt lgkmcnt(3)
    v_smfmac_f32_32x32x32_bf16 v[16:31], v[72:75], v[48:55], v7
    ds_read_b128 v[72:75], v5 offset:18432
    s_waitcnt lgkmcnt(3)
    v_smfmac_f32_32x32x32_bf16 v[16:31], v[76:79], v[56:63], v7
    ds_read_b128 v[76:79], v5 offset:19456
    s_setprio 0
    v_exp_f32 v32, v32
    v_exp_f32 v33, v33
    v_exp_f32 v34, v34
    v_exp_f32 v35, v35
    v_exp_f32 v36, v36
    v_exp_f32 v37, v37
    v_exp_f32 v38, v38
    v_exp_f32 v39, v39
    s_setprio 1
    v_exp_f32 v40, v40
    v_exp_f32 v41, v41
    v_exp_f32 v42, v42
    v_exp_f32 v43, v43
    v_exp_f32 v44, v44
    v_exp_f32 v45, v45
    v_exp_f32 v46, v46
    v_exp_f32 v47, v47
    s_waitcnt vmcnt(8)
    s_barrier
    s_setprio 2
    s_waitcnt lgkmcnt(3)
    v_mfma_f32_32x32x16_bf16 v[48:63], v[64:67], v[80:83], 0
    ds_read_b128 v[64:67], v5 offset:32768
    s_add_u32 m0, s71, 147456
    s_add_u32 s54, s54, 16384
    s_and_b32 s54, s54, 245760
    buffer_load_dwordx4 v96, s[12:15], s54 offen offset:0 sc1 lds
    s_waitcnt lgkmcnt(3)
    v_mfma_f32_32x32x16_bf16 v[48:63], v[68:71], v[84:87], v[48:63]
    ds_read_b128 v[68:71], v5 offset:33792
    buffer_load_dwordx4 v96, s[12:15], s54 offen offset:1024 sc1 lds
    s_waitcnt lgkmcnt(3)
    v_smfmac_f32_32x32x32_bf16 v[16:31], v[72:75], v[32:39], v7
    ds_read_b128 v[72:75], v5 offset:22528
    s_waitcnt lgkmcnt(3)
    v_smfmac_f32_32x32x32_bf16 v[16:31], v[76:79], v[40:47], v7
    ds_read_b128 v[76:79], v5 offset:23552
    s_setprio 0
    v_exp_f32 v48, v48
    v_exp_f32 v49, v49
    v_exp_f32 v50, v50
    v_exp_f32 v51, v51
    v_exp_f32 v52, v52
    v_exp_f32 v53, v53
    v_exp_f32 v54, v54
    v_exp_f32 v55, v55
    s_setprio 1
    v_exp_f32 v56, v56
    v_exp_f32 v57, v57
    v_exp_f32 v58, v58
    v_exp_f32 v59, v59
    v_exp_f32 v60, v60
    v_exp_f32 v61, v61
    v_exp_f32 v62, v62
    v_exp_f32 v63, v63
    s_setprio 2
    s_waitcnt lgkmcnt(3)
    v_mfma_f32_32x32x16_bf16 v[32:47], v[64:67], v[80:83], 0
    ds_read_b128 v[64:67], v5 offset:36864
    buffer_load_dwordx4 v96, s[12:15], s54 offen offset:2048 sc1 lds
    s_waitcnt lgkmcnt(3)
    v_mfma_f32_32x32x16_bf16 v[32:47], v[68:71], v[84:87], v[32:47]
    ds_read_b128 v[68:71], v5 offset:37888
    buffer_load_dwordx4 v96, s[12:15], s54 offen offset:3072 sc1 lds
    s_waitcnt lgkmcnt(3)
    v_smfmac_f32_32x32x32_bf16 v[16:31], v[72:75], v[48:55], v7
    ds_read_b128 v[72:75], v5 offset:34816
    s_waitcnt lgkmcnt(3)
    v_smfmac_f32_32x32x32_bf16 v[16:31], v[76:79], v[56:63], v7
    ds_read_b128 v[76:79], v5 offset:35840
    s_setprio 0
    v_exp_f32 v32, v32
    v_exp_f32 v33, v33
    v_exp_f32 v34, v34
    v_exp_f32 v35, v35
    v_exp_f32 v36, v36
    v_exp_f32 v37, v37
    v_exp_f32 v38, v38
    v_exp_f32 v39, v39
    s_setprio 1
    v_exp_f32 v40, v40
    v_exp_f32 v41, v41
    v_exp_f32 v42, v42
    v_exp_f32 v43, v43
    v_exp_f32 v44, v44
    v_exp_f32 v45, v45
    v_exp_f32 v46, v46
    v_exp_f32 v47, v47
    s_waitcnt vmcnt(8)
    s_barrier
    s_setprio 2
    s_waitcnt lgkmcnt(3)
    v_mfma_f32_32x32x16_bf16 v[48:63], v[64:67], v[80:83], 0
    ds_read_b128 v[64:67], v5 offset:49152
    s_add_u32 m0, s71, 81920
    s_add_u32 s54, s54, 16384
    s_and_b32 s54, s54, 245760
    buffer_load_dwordx4 v96, s[12:15], s54 offen offset:3072 sc1 lds
    s_waitcnt lgkmcnt(3)
    v_mfma_f32_32x32x16_bf16 v[48:63], v[68:71], v[84:87], v[48:63]
    ds_read_b128 v[68:71], v5 offset:50176
    buffer_load_dwordx4 v[128:131], v1, s[12:15], s70 offen offset:0 sc1
    s_waitcnt lgkmcnt(3)
    v_smfmac_f32_32x32x32_bf16 v[16:31], v[72:75], v[32:39], v7
    ds_read_b128 v[72:75], v5 offset:38912
    s_waitcnt lgkmcnt(3)
    v_smfmac_f32_32x32x32_bf16 v[16:31], v[76:79], v[40:47], v7
    ds_read_b128 v[76:79], v5 offset:39936
    s_setprio 0
    v_exp_f32 v48, v48
    v_exp_f32 v49, v49
    v_exp_f32 v50, v50
    v_exp_f32 v51, v51
    v_exp_f32 v52, v52
    v_exp_f32 v53, v53
    v_exp_f32 v54, v54
    v_exp_f32 v55, v55
    s_setprio 1
    v_exp_f32 v56, v56
    v_exp_f32 v57, v57
    v_exp_f32 v58, v58
    v_exp_f32 v59, v59
    v_exp_f32 v60, v60
    v_exp_f32 v61, v61
    v_exp_f32 v62, v62
    v_exp_f32 v63, v63
    s_setprio 2
    s_waitcnt lgkmcnt(3)
    v_mfma_f32_32x32x16_bf16 v[32:47], v[64:67], v[80:83], 0
    ds_read_b128 v[64:67], v5 offset:53248
    buffer_load_dwordx4 v[132:135], v1, s[12:15], s70 offen offset:1024 sc1
    s_waitcnt lgkmcnt(3)
    v_mfma_f32_32x32x16_bf16 v[32:47], v[68:71], v[84:87], v[32:47]
    ds_read_b128 v[68:71], v5 offset:54272
    buffer_load_dwordx4 v[136:139], v1, s[12:15], s70 offen offset:2048 sc1
    s_waitcnt lgkmcnt(3)
    v_smfmac_f32_32x32x32_bf16 v[16:31], v[72:75], v[48:55], v7
    ds_read_b128 v[72:75], v5 offset:51200
    s_waitcnt lgkmcnt(3)
    v_smfmac_f32_32x32x32_bf16 v[16:31], v[76:79], v[56:63], v7
    ds_read_b128 v[76:79], v5 offset:52224
    s_setprio 0
    v_exp_f32 v32, v32
    v_exp_f32 v33, v33
    v_exp_f32 v34, v34
    v_exp_f32 v35, v35
    v_exp_f32 v36, v36
    v_exp_f32 v37, v37
    v_exp_f32 v38, v38
    v_exp_f32 v39, v39
    s_setprio 1
    v_exp_f32 v40, v40
    v_exp_f32 v41, v41
    v_exp_f32 v42, v42
    v_exp_f32 v43, v43
    v_exp_f32 v44, v44
    v_exp_f32 v45, v45
    v_exp_f32 v46, v46
    v_exp_f32 v47, v47
    s_waitcnt vmcnt(8)
    s_barrier
    s_setprio 2
    s_waitcnt lgkmcnt(3)
    v_mfma_f32_32x32x16_bf16 v[48:63], v[64:67], v[80:83], 0
    ds_read_b128 v[64:67], v6 offset:0
    s_add_u32 m0, s71, 98304
    s_add_u32 s54, s54, 16384
    s_and_b32 s54, s54, 245760
    buffer_load_dwordx4 v96, s[12:15], s54 offen offset:2048 sc1 lds
    s_waitcnt lgkmcnt(3)
    v_mfma_f32_32x32x16_bf16 v[48:63], v[68:71], v[84:87], v[48:63]
    ds_read_b128 v[68:71], v6 offset:1024
    buffer_load_dwordx4 v96, s[12:15], s54 offen offset:3072 sc1 lds
    s_waitcnt lgkmcnt(3)
    v_smfmac_f32_32x32x32_bf16 v[16:31], v[72:75], v[32:39], v7
    ds_read_b128 v[72:75], v5 offset:55296
    s_waitcnt lgkmcnt(3)
    v_smfmac_f32_32x32x32_bf16 v[16:31], v[76:79], v[40:47], v7
    ds_read_b128 v[76:79], v5 offset:56320
    s_setprio 0
    v_exp_f32 v48, v48
    v_exp_f32 v49, v49
    v_exp_f32 v50, v50
    v_exp_f32 v51, v51
    v_exp_f32 v52, v52
    v_exp_f32 v53, v53
    v_exp_f32 v54, v54
    v_exp_f32 v55, v55
    s_setprio 1
    v_exp_f32 v56, v56
    v_exp_f32 v57, v57
    v_exp_f32 v58, v58
    v_exp_f32 v59, v59
    v_exp_f32 v60, v60
    v_exp_f32 v61, v61
    v_exp_f32 v62, v62
    v_exp_f32 v63, v63
    s_setprio 2
    s_waitcnt lgkmcnt(3)
    v_mfma_f32_32x32x16_bf16 v[32:47], v[64:67], v[80:83], 0
    ds_read_b128 v[64:67], v6 offset:4096
    buffer_load_dwordx4 v[140:143], v1, s[12:15], s70 offen offset:3072 sc1
    s_add_u32 s70, s70, 4096
    s_waitcnt lgkmcnt(3)
    v_mfma_f32_32x32x16_bf16 v[32:47], v[68:71], v[84:87], v[32:47]
    ds_read_b128 v[68:71], v6 offset:5120
    buffer_load_dwordx4 v[144:147], v1, s[12:15], s70 offen offset:0 sc1
    s_waitcnt lgkmcnt(3)
    v_smfmac_f32_32x32x32_bf16 v[16:31], v[72:75], v[48:55], v7
    ds_read_b128 v[72:75], v6 offset:2048
    buffer_load_dwordx4 v[148:151], v1, s[12:15], s70 offen offset:1024 sc1
    s_waitcnt lgkmcnt(3)
    v_smfmac_f32_32x32x32_bf16 v[16:31], v[76:79], v[56:63], v7
    ds_read_b128 v[76:79], v6 offset:3072
    s_setprio 0
    v_exp_f32 v32, v32
    v_exp_f32 v33, v33
    v_exp_f32 v34, v34
    v_exp_f32 v35, v35
    v_exp_f32 v36, v36
    v_exp_f32 v37, v37
    v_exp_f32 v38, v38
    v_exp_f32 v39, v39
    s_setprio 1
    v_exp_f32 v40, v40
    v_exp_f32 v41, v41
    v_exp_f32 v42, v42
    v_exp_f32 v43, v43
    v_exp_f32 v44, v44
    v_exp_f32 v45, v45
    v_exp_f32 v46, v46
    v_exp_f32 v47, v47
    s_waitcnt vmcnt(9)
    s_barrier
    s_setprio 2
    s_waitcnt lgkmcnt(3)
    v_mfma_f32_32x32x16_bf16 v[48:63], v[64:67], v[80:83], 0
    ds_read_b128 v[64:67], v6 offset:16384
    s_add_u32 m0, s71, 114688
    s_add_u32 s54, s54, 16384
    s_and_b32 s54, s54, 245760
    buffer_load_dwordx4 v96, s[12:15], s54 offen offset:3072 sc1 lds
    s_waitcnt lgkmcnt(3)
    v_mfma_f32_32x32x16_bf16 v[48:63], v[68:71], v[84:87], v[48:63]
    ds_read_b128 v[68:71], v6 offset:17408
    buffer_load_dwordx4 v[152:155], v1, s[12:15], s70 offen offset:2048 sc1
    s_waitcnt lgkmcnt(3)
    v_smfmac_f32_32x32x32_bf16 v[16:31], v[72:75], v[32:39], v7
    ds_read_b128 v[72:75], v6 offset:6144
    s_waitcnt lgkmcnt(3)
    v_smfmac_f32_32x32x32_bf16 v[16:31], v[76:79], v[40:47], v7
    ds_read_b128 v[76:79], v6 offset:7168
    s_setprio 0
    v_exp_f32 v48, v48
    v_exp_f32 v49, v49
    v_exp_f32 v50, v50
    v_exp_f32 v51, v51
    v_exp_f32 v52, v52
    v_exp_f32 v53, v53
    v_exp_f32 v54, v54
    v_exp_f32 v55, v55
    s_setprio 1
    v_exp_f32 v56, v56
    v_exp_f32 v57, v57
    v_exp_f32 v58, v58
    v_exp_f32 v59, v59
    v_exp_f32 v60, v60
    v_exp_f32 v61, v61
    v_exp_f32 v62, v62
    v_exp_f32 v63, v63
    s_setprio 2
    s_waitcnt lgkmcnt(3)
    v_mfma_f32_32x32x16_bf16 v[32:47], v[64:67], v[80:83], 0
    ds_read_b128 v[64:67], v6 offset:20480
    buffer_load_dwordx4 v[156:159], v1, s[12:15], s70 offen offset:3072 sc1
    s_add_u32 s70, s70, 4096
    s_waitcnt lgkmcnt(3)
    v_mfma_f32_32x32x16_bf16 v[32:47], v[68:71], v[84:87], v[32:47]
    ds_read_b128 v[68:71], v6 offset:21504
    buffer_load_dwordx4 v[160:163], v1, s[12:15], s70 offen offset:0 sc1
    s_waitcnt lgkmcnt(3)
    v_smfmac_f32_32x32x32_bf16 v[16:31], v[72:75], v[48:55], v7
    ds_read_b128 v[72:75], v6 offset:18432
    s_waitcnt lgkmcnt(3)
    v_smfmac_f32_32x32x32_bf16 v[16:31], v[76:79], v[56:63], v7
    ds_read_b128 v[76:79], v6 offset:19456
    s_setprio 0
    v_exp_f32 v32, v32
    v_exp_f32 v33, v33
    v_exp_f32 v34, v34
    v_exp_f32 v35, v35
    v_exp_f32 v36, v36
    v_exp_f32 v37, v37
    v_exp_f32 v38, v38
    v_exp_f32 v39, v39
    s_setprio 1
    v_exp_f32 v40, v40
    v_exp_f32 v41, v41
    v_exp_f32 v42, v42
    v_exp_f32 v43, v43
    v_exp_f32 v44, v44
    v_exp_f32 v45, v45
    v_exp_f32 v46, v46
    v_exp_f32 v47, v47
    s_waitcnt vmcnt(12)
    s_barrier
    s_setprio 2
    s_waitcnt lgkmcnt(3)
    v_mfma_f32_32x32x16_bf16 v[48:63], v[64:67], v[80:83], 0
    ds_read_b128 v[64:67], v5 offset:16384
    s_add_u32 m0, s71, 131072
    s_add_u32 s54, s54, 16384
    s_and_b32 s54, s54, 245760
    buffer_load_dwordx4 v96, s[12:15], s54 offen offset:3072 sc1 lds
    s_waitcnt lgkmcnt(3)
    v_mfma_f32_32x32x16_bf16 v[48:63], v[68:71], v[84:87], v[48:63]
    ds_read_b128 v[68:71], v5 offset:17408
    buffer_load_dwordx4 v[164:167], v1, s[12:15], s70 offen offset:1024 sc1
    s_waitcnt lgkmcnt(3)
    v_smfmac_f32_32x32x32_bf16 v[16:31], v[72:75], v[32:39], v7
    ds_read_b128 v[72:75], v6 offset:22528
    s_waitcnt lgkmcnt(3)
    v_smfmac_f32_32x32x32_bf16 v[16:31], v[76:79], v[40:47], v7
    ds_read_b128 v[76:79], v6 offset:23552
    s_setprio 0
    v_exp_f32 v48, v48
    v_exp_f32 v49, v49
    v_exp_f32 v50, v50
    v_exp_f32 v51, v51
    v_exp_f32 v52, v52
    v_exp_f32 v53, v53
    v_exp_f32 v54, v54
    v_exp_f32 v55, v55
    s_setprio 1
    v_exp_f32 v56, v56
    v_exp_f32 v57, v57
    v_exp_f32 v58, v58
    v_exp_f32 v59, v59
    v_exp_f32 v60, v60
    v_exp_f32 v61, v61
    v_exp_f32 v62, v62
    v_exp_f32 v63, v63
    s_setprio 2
    s_waitcnt lgkmcnt(3)
    v_mfma_f32_32x32x16_bf16 v[32:47], v[64:67], v[80:83], 0
    ds_read_b128 v[64:67], v5 offset:20480
    buffer_load_dwordx4 v[168:171], v1, s[12:15], s70 offen offset:2048 sc1
    s_waitcnt lgkmcnt(3)
    v_mfma_f32_32x32x16_bf16 v[32:47], v[68:71], v[84:87], v[32:47]
    ds_read_b128 v[68:71], v5 offset:21504
    buffer_load_dwordx4 v[172:175], v1, s[12:15], s70 offen offset:3072 sc1
    s_add_u32 s70, s70, 4096
    s_waitcnt lgkmcnt(3)
    v_smfmac_f32_32x32x32_bf16 v[16:31], v[72:75], v[48:55], v7
    ds_read_b128 v[72:75], v5 offset:18432
    buffer_load_dwordx4 v[176:179], v1, s[12:15], s70 offen offset:0 sc1
    s_waitcnt lgkmcnt(3)
    v_smfmac_f32_32x32x32_bf16 v[16:31], v[76:79], v[56:63], v7
    ds_read_b128 v[76:79], v5 offset:19456
    s_setprio 0
    v_exp_f32 v32, v32
    v_exp_f32 v33, v33
    v_exp_f32 v34, v34
    v_exp_f32 v35, v35
    v_exp_f32 v36, v36
    v_exp_f32 v37, v37
    v_exp_f32 v38, v38
    v_exp_f32 v39, v39
    s_setprio 1
    v_exp_f32 v40, v40
    v_exp_f32 v41, v41
    v_exp_f32 v42, v42
    v_exp_f32 v43, v43
    v_exp_f32 v44, v44
    v_exp_f32 v45, v45
    v_exp_f32 v46, v46
    v_exp_f32 v47, v47
    s_waitcnt vmcnt(12)
    s_barrier
    s_setprio 2
    s_waitcnt lgkmcnt(3)
    v_mfma_f32_32x32x16_bf16 v[48:63], v[64:67], v[80:83], 0
    ds_read_b128 v[64:67], v5 offset:32768
    buffer_load_dwordx4 v[180:183], v1, s[12:15], s70 offen offset:1024 sc1
    s_waitcnt lgkmcnt(3)
    v_mfma_f32_32x32x16_bf16 v[48:63], v[68:71], v[84:87], v[48:63]
    ds_read_b128 v[68:71], v5 offset:33792
    buffer_load_dwordx4 v[184:187], v1, s[12:15], s70 offen offset:2048 sc1
    s_waitcnt lgkmcnt(3)
    v_smfmac_f32_32x32x32_bf16 v[16:31], v[72:75], v[32:39], v7
    ds_read_b128 v[72:75], v5 offset:22528
    s_waitcnt lgkmcnt(3)
    v_smfmac_f32_32x32x32_bf16 v[16:31], v[76:79], v[40:47], v7
    ds_read_b128 v[76:79], v5 offset:23552
    s_setprio 0
    v_exp_f32 v48, v48
    v_exp_f32 v49, v49
    v_exp_f32 v50, v50
    v_exp_f32 v51, v51
    v_exp_f32 v52, v52
    v_exp_f32 v53, v53
    v_exp_f32 v54, v54
    v_exp_f32 v55, v55
    s_setprio 1
    v_exp_f32 v56, v56
    v_exp_f32 v57, v57
    v_exp_f32 v58, v58
    v_exp_f32 v59, v59
    v_exp_f32 v60, v60
    v_exp_f32 v61, v61
    v_exp_f32 v62, v62
    v_exp_f32 v63, v63
    s_setprio 2
    s_waitcnt lgkmcnt(3)
    v_mfma_f32_32x32x16_bf16 v[32:47], v[64:67], v[80:83], 0
    ds_read_b128 v[64:67], v5 offset:36864
    buffer_load_dwordx4 v[188:191], v1, s[12:15], s70 offen offset:3072 sc1
    s_add_u32 s70, s70, 4096
    s_waitcnt lgkmcnt(3)
    v_mfma_f32_32x32x16_bf16 v[32:47], v[68:71], v[84:87], v[32:47]
    ds_read_b128 v[68:71], v5 offset:37888
    buffer_load_dwordx4 v[192:195], v1, s[12:15], s70 offen offset:0 sc1
    s_waitcnt lgkmcnt(3)
    v_smfmac_f32_32x32x32_bf16 v[16:31], v[72:75], v[48:55], v7
    ds_read_b128 v[72:75], v5 offset:34816
    s_waitcnt lgkmcnt(3)
    v_smfmac_f32_32x32x32_bf16 v[16:31], v[76:79], v[56:63], v7
    ds_read_b128 v[76:79], v5 offset:35840
    s_setprio 0
    v_exp_f32 v32, v32
    v_exp_f32 v33, v33
    v_exp_f32 v34, v34
    v_exp_f32 v35, v35
    v_exp_f32 v36, v36
    v_exp_f32 v37, v37
    v_exp_f32 v38, v38
    v_exp_f32 v39, v39
    s_setprio 1
    v_exp_f32 v40, v40
    v_exp_f32 v41, v41
    v_exp_f32 v42, v42
    v_exp_f32 v43, v43
    v_exp_f32 v44, v44
    v_exp_f32 v45, v45
    v_exp_f32 v46, v46
    v_exp_f32 v47, v47
    s_waitcnt vmcnt(12)
    s_barrier
    s_setprio 2
    s_waitcnt lgkmcnt(3)
    v_mfma_f32_32x32x16_bf16 v[48:63], v[64:67], v[80:83], 0
    ds_read_b128 v[64:67], v5 offset:49152
    buffer_load_dwordx4 v[196:199], v1, s[12:15], s70 offen offset:1024 sc1
    s_waitcnt lgkmcnt(3)
    v_mfma_f32_32x32x16_bf16 v[48:63], v[68:71], v[84:87], v[48:63]
    ds_read_b128 v[68:71], v5 offset:50176
    buffer_load_dwordx4 v[200:203], v1, s[12:15], s70 offen offset:2048 sc1
    s_waitcnt lgkmcnt(3)
    v_smfmac_f32_32x32x32_bf16 v[16:31], v[72:75], v[32:39], v7
    ds_read_b128 v[72:75], v5 offset:38912
    s_waitcnt lgkmcnt(3)
    v_smfmac_f32_32x32x32_bf16 v[16:31], v[76:79], v[40:47], v7
    ds_read_b128 v[76:79], v5 offset:39936
    s_setprio 0
    v_exp_f32 v48, v48
    v_exp_f32 v49, v49
    v_exp_f32 v50, v50
    v_exp_f32 v51, v51
    v_exp_f32 v52, v52
    v_exp_f32 v53, v53
    v_exp_f32 v54, v54
    v_exp_f32 v55, v55
    s_setprio 1
    v_exp_f32 v56, v56
    v_exp_f32 v57, v57
    v_exp_f32 v58, v58
    v_exp_f32 v59, v59
    v_exp_f32 v60, v60
    v_exp_f32 v61, v61
    v_exp_f32 v62, v62
    v_exp_f32 v63, v63
    s_setprio 2
    s_waitcnt lgkmcnt(3)
    v_mfma_f32_32x32x16_bf16 v[32:47], v[64:67], v[80:83], 0
    ds_read_b128 v[64:67], v5 offset:53248
    buffer_load_dwordx4 v[204:207], v1, s[12:15], s70 offen offset:3072 sc1
    s_add_u32 s70, s70, 4096
    s_waitcnt lgkmcnt(3)
    v_mfma_f32_32x32x16_bf16 v[32:47], v[68:71], v[84:87], v[32:47]
    ds_read_b128 v[68:71], v5 offset:54272
    buffer_load_dwordx4 v[208:211], v1, s[12:15], s70 offen offset:0 sc1
    s_waitcnt lgkmcnt(3)
    v_smfmac_f32_32x32x32_bf16 v[16:31], v[72:75], v[48:55], v7
    ds_read_b128 v[72:75], v5 offset:51200
    buffer_load_dwordx4 v[212:215], v1, s[12:15], s70 offen offset:1024 sc1
    s_waitcnt lgkmcnt(3)
    v_smfmac_f32_32x32x32_bf16 v[16:31], v[76:79], v[56:63], v7
    ds_read_b128 v[76:79], v5 offset:52224
    s_setprio 0
    v_exp_f32 v32, v32
    v_exp_f32 v33, v33
    v_exp_f32 v34, v34
    v_exp_f32 v35, v35
    v_exp_f32 v36, v36
    v_exp_f32 v37, v37
    v_exp_f32 v38, v38
    v_exp_f32 v39, v39
    s_setprio 1
    v_exp_f32 v40, v40
    v_exp_f32 v41, v41
    v_exp_f32 v42, v42
    v_exp_f32 v43, v43
    v_exp_f32 v44, v44
    v_exp_f32 v45, v45
    v_exp_f32 v46, v46
    v_exp_f32 v47, v47
    s_waitcnt vmcnt(13)
    s_barrier
    s_setprio 2
    s_waitcnt lgkmcnt(3)
    v_mfma_f32_32x32x16_bf16 v[48:63], v[64:67], v[80:83], 0
    ds_read_b128 v[64:67], v6 offset:0
    buffer_load_dwordx4 v[216:219], v1, s[12:15], s70 offen offset:2048 sc1
    s_waitcnt lgkmcnt(3)
    v_mfma_f32_32x32x16_bf16 v[48:63], v[68:71], v[84:87], v[48:63]
    ds_read_b128 v[68:71], v6 offset:1024
    buffer_load_dwordx4 v[220:223], v1, s[12:15], s70 offen offset:3072 sc1
    s_add_u32 s70, s70, 4096
    s_waitcnt lgkmcnt(3)
    v_smfmac_f32_32x32x32_bf16 v[16:31], v[72:75], v[32:39], v7
    ds_read_b128 v[72:75], v5 offset:55296
    s_waitcnt lgkmcnt(3)
    v_smfmac_f32_32x32x32_bf16 v[16:31], v[76:79], v[40:47], v7
    ds_read_b128 v[76:79], v5 offset:56320
    s_setprio 0
    v_exp_f32 v48, v48
    v_exp_f32 v49, v49
    v_exp_f32 v50, v50
    v_exp_f32 v51, v51
    v_exp_f32 v52, v52
    v_exp_f32 v53, v53
    v_exp_f32 v54, v54
    v_exp_f32 v55, v55
    s_setprio 1
    v_exp_f32 v56, v56
    v_exp_f32 v57, v57
    v_exp_f32 v58, v58
    v_exp_f32 v59, v59
    v_exp_f32 v60, v60
    v_exp_f32 v61, v61
    v_exp_f32 v62, v62
    v_exp_f32 v63, v63
    s_setprio 2
    s_waitcnt lgkmcnt(3)
    v_mfma_f32_32x32x16_bf16 v[32:47], v[64:67], v[80:83], 0
    ds_read_b128 v[64:67], v6 offset:4096
    buffer_load_dwordx4 v[224:227], v1, s[12:15], s70 offen offset:0 sc1
    s_waitcnt lgkmcnt(3)
    v_mfma_f32_32x32x16_bf16 v[32:47], v[68:71], v[84:87], v[32:47]
    ds_read_b128 v[68:71], v6 offset:5120
    buffer_load_dwordx4 v[228:231], v1, s[12:15], s70 offen offset:1024 sc1
    s_waitcnt lgkmcnt(3)
    v_smfmac_f32_32x32x32_bf16 v[16:31], v[72:75], v[48:55], v7
    ds_read_b128 v[72:75], v6 offset:2048
    s_waitcnt lgkmcnt(3)
    v_smfmac_f32_32x32x32_bf16 v[16:31], v[76:79], v[56:63], v7
    ds_read_b128 v[76:79], v6 offset:3072
    s_setprio 0
    v_exp_f32 v32, v32
    v_exp_f32 v33, v33
    v_exp_f32 v34, v34
    v_exp_f32 v35, v35
    v_exp_f32 v36, v36
    v_exp_f32 v37, v37
    v_exp_f32 v38, v38
    v_exp_f32 v39, v39
    s_setprio 1
    v_exp_f32 v40, v40
    v_exp_f32 v41, v41
    v_exp_f32 v42, v42
    v_exp_f32 v43, v43
    v_exp_f32 v44, v44
    v_exp_f32 v45, v45
    v_exp_f32 v46, v46
    v_exp_f32 v47, v47
    s_setprio 2
    s_waitcnt lgkmcnt(3)
    v_mfma_f32_32x32x16_bf16 v[48:63], v[64:67], v[80:83], 0
    buffer_load_dwordx4 v[232:235], v1, s[12:15], s70 offen offset:2048 sc1
    s_waitcnt lgkmcnt(2)
    v_mfma_f32_32x32x16_bf16 v[48:63], v[68:71], v[84:87], v[48:63]
    buffer_load_dwordx4 v[236:239], v1, s[12:15], s70 offen offset:3072 sc1
    s_add_u32 s70, s70, 4096
    s_waitcnt lgkmcnt(1)
    v_smfmac_f32_32x32x32_bf16 v[16:31], v[72:75], v[32:39], v7
    ds_read_b128 v[72:75], v6 offset:6144
    s_waitcnt lgkmcnt(1)
    v_smfmac_f32_32x32x32_bf16 v[16:31], v[76:79], v[40:47], v7
    ds_read_b128 v[76:79], v6 offset:7168
    s_setprio 0
    v_exp_f32 v48, v48
    v_exp_f32 v49, v49
    v_exp_f32 v50, v50
    v_exp_f32 v51, v51
    v_exp_f32 v52, v52
    v_exp_f32 v53, v53
    v_exp_f32 v54, v54
    v_exp_f32 v55, v55
    s_setprio 1
    v_exp_f32 v56, v56
    v_exp_f32 v57, v57
    v_exp_f32 v58, v58
    v_exp_f32 v59, v59
    v_exp_f32 v60, v60
    v_exp_f32 v61, v61
    v_exp_f32 v62, v62
    v_exp_f32 v63, v63
    s_setprio 2
    buffer_load_dwordx4 v[240:243], v1, s[12:15], s70 offen offset:0 sc1
    buffer_load_dwordx4 v[244:247], v1, s[12:15], s70 offen offset:1024 sc1
    s_waitcnt lgkmcnt(1)
    v_smfmac_f32_32x32x32_bf16 v[16:31], v[72:75], v[48:55], v7
    buffer_load_dwordx4 v[248:251], v1, s[12:15], s70 offen offset:2048 sc1
    s_waitcnt lgkmcnt(0)
    v_smfmac_f32_32x32x32_bf16 v[16:31], v[76:79], v[56:63], v7
    s_add_u32 s28, s71, 147456
    v_add_u32 v3, s28, v1
    s_nop 9
    ds_write_b128 v3, v[16:19] offset:0
    ds_write_b128 v3, v[20:23] offset:1024
    ds_write_b128 v3, v[24:27] offset:2048
    ds_write_b128 v3, v[28:31] offset:3072
    s_and_b32 s29, s72, 7
    s_lshl_b32 s29, s29, 15
    s_add_u32 s29, s29, s99
    s_add_u32 s29, s29, 786432
    s_lshl_b32 s30, s3, 13
    s_add_u32 s29, s29, s30
    s_add_u32 s31, s29, 4096
    s_add_u32 m0, s30, 114688
    v_add_u32 v3, 114688, v1
    s_mul_i32 s28, s3, 8192
    s_add_u32 s28, s28, 114688
    v_lshrrev_b32 v4, 2, v0
    v_lshl_add_u32 v4, v4, 4, v1
    v_add_u32 v4, s28, v4
    v_and_b32 v5, 31, v0
    v_mul_u32_u24 v5, 80, v5
    v_lshrrev_b32 v7, 5, v0
    v_lshl_add_u32 v5, v7, 3, v5
    v_add_u32 v5, s28, v5
    v_mov_b32 v6, s24
    v_min_u32 v102, 7, v0
    v_lshlrev_b32 v102, 10, v102
    s_waitcnt lgkmcnt(0)
    s_barrier
    s_waitcnt vmcnt(8)
    ds_write_b128 v4, v[88:91]
    ds_write_b128 v4, v[92:95] offset:1280
    ds_read_b64 v[88:89], v5 offset:0
    ds_read_b64 v[90:91], v5 offset:16
    ds_read_b64 v[92:93], v5 offset:32
    ds_read_b64 v[94:95], v5 offset:48
    s_waitcnt lgkmcnt(0)
    v_lshlrev_b32 v16, 16, v88
    v_and_b32 v17, 0xffff0000, v88
    v_lshlrev_b32 v18, 16, v89
    v_and_b32 v19, 0xffff0000, v89
    v_lshlrev_b32 v20, 16, v90
    v_and_b32 v21, 0xffff0000, v90
    v_lshlrev_b32 v22, 16, v91
    v_and_b32 v23, 0xffff0000, v91
    v_lshlrev_b32 v24, 16, v92
    v_and_b32 v25, 0xffff0000, v92
    v_lshlrev_b32 v26, 16, v93
    v_and_b32 v27, 0xffff0000, v93
    v_lshlrev_b32 v28, 16, v94
    v_and_b32 v29, 0xffff0000, v94
    v_lshlrev_b32 v30, 16, v95
    v_and_b32 v31, 0xffff0000, v95
    s_or_b32 s56, s2, s3
    s_cmp_eq_u32 s56, 0
    s_cselect_b32 s56, 0, 1073741824
    s_mul_i32 s57, s72, 28
    s_lshl1_add_u32 s57, s73, s57
    s_lshl_b32 s57, s57, 10
    s_add_u32 s57, s57, 3670016
    s_lshl_b32 s58, s4, 5
    s_add_u32 s58, s58, s5
    s_lshl_b32 s58, s58, 8
    s_add_u32 s58, s58, s3
    s_lshl_b32 s58, s58, 2
    s_add_u32 s58, s58, 3407872
    s_cmp_lt_u32 s73, 14
    s_cselect_b32 s57, s57, 1073741824
    s_lshl_b32 s59, s72, 5
    s_add_u32 s59, s59, s73
    s_lshl_b32 s59, s59, 2
    s_add_u32 s59, s59, 16384
    v_bfe_u32 v8, v0, 2, 2
    v_lshrrev_b32 v9, 5, v0
    v_lshl_add_u32 v9, v9, 2, v8
    v_lshlrev_b32 v9, 8, v9
    v_bfe_u32 v10, v0, 4, 1
    v_lshl_add_u32 v9, v10, 5, v9
    v_and_b32 v10, 3, v0
    v_lshl_add_u32 v9, v10, 3, v9
    v_lshrrev_b32 v10, 5, v0
    v_lshlrev_b32 v10, 4, v10
    v_xor_b32 v9, v9, v10
    v_xor_b32 v10, s68, v8
    v_lshl_add_u32 v98, v10, 6, v9
    v_add_u32 v99, 65536, v98
    v_mov_b32 v100, 0
    v_mov_b32 v101, 0
    v_mul_u32_u24 v5, 0x410000, v0
    v_xor_b32 v5, s24, v5
    v_and_b32 v5, 0x9fff0000, v5
    v_or_b32 v5, 0x20000000, v5
    v_add_u32 v7, s30, v3
    s_and_b32 s38, s5, 3
    s_lshl_b32 s39, s38, 7
    s_lshl_b32 s38, s38, 3
    s_sub_u32 s38, 63, s38
    s_sub_u32 s39, s29, s39
    v_readlane_b32 s32, v5, s38
    v_readlane_b32 s33, v5, s38
    s_add_u32 s36, s12, s39
    s_addc_u32 s37, s13, 0
    ds_read_b64_tr_b16 v[40:41], v98 offset:0
    ds_read_b64_tr_b16 v[42:43], v98 offset:2048
    ds_read_b64_tr_b16 v[44:45], v98 offset:4096
    ds_read_b64_tr_b16 v[46:47], v98 offset:6144
    ds_read_b64_tr_b16 v[48:49], v98 offset:8192
    ds_read_b64_tr_b16 v[50:51], v98 offset:10240
    ds_read_b64_tr_b16 v[52:53], v98 offset:12288
    ds_read_b64_tr_b16 v[54:55], v98 offset:14336
    ds_read_b64_tr_b16 v[56:57], v98 offset:16384
    ds_read_b64_tr_b16 v[58:59], v98 offset:18432
    ds_read_b64_tr_b16 v[60:61], v98 offset:20480
    ds_read_b64_tr_b16 v[62:63], v98 offset:22528
    s_waitcnt lgkmcnt(10)
    v_dot2c_f32_bf16 v100, s92, v40
    v_dot2c_f32_bf16 v101, s92, v41
    v_dot2c_f32_bf16 v100, s92, v42
    v_dot2c_f32_bf16 v101, s92, v43
    ds_read_b64_tr_b16 v[40:41], v98 offset:24576
    ds_read_b64_tr_b16 v[42:43], v98 offset:26624
    s_waitcnt lgkmcnt(10)
    v_dot2c_f32_bf16 v100, s92, v44
    v_dot2c_f32_bf16 v101, s92, v45
    v_dot2c_f32_bf16 v100, s92, v46
    v_dot2c_f32_bf16 v101, s92, v47
    ds_read_b64_tr_b16 v[44:45], v98 offset:28672
    ds_read_b64_tr_b16 v[46:47], v98 offset:30720
    s_waitcnt lgkmcnt(10)
    v_dot2c_f32_bf16 v100, s92, v48
    v_dot2c_f32_bf16 v101, s92, v49
    v_dot2c_f32_bf16 v100, s92, v50
    v_dot2c_f32_bf16 v101, s92, v51
    s_waitcnt lgkmcnt(8)
    v_dot2c_f32_bf16 v100, s92, v52
    v_dot2c_f32_bf16 v101, s92, v53
    v_dot2c_f32_bf16 v100, s92, v54
    v_dot2c_f32_bf16 v101, s92, v55
    s_waitcnt lgkmcnt(6)
    v_dot2c_f32_bf16 v100, s92, v56
    v_dot2c_f32_bf16 v101, s92, v57
    v_dot2c_f32_bf16 v100, s92, v58
    v_dot2c_f32_bf16 v101, s92, v59
    s_waitcnt lgkmcnt(4)
    v_dot2c_f32_bf16 v100, s92, v60
    v_dot2c_f32_bf16 v101, s92, v61
    v_dot2c_f32_bf16 v100, s92, v62
    v_dot2c_f32_bf16 v101, s92, v63
    s_waitcnt lgkmcnt(2)
    v_dot2c_f32_bf16 v100, s92, v40
    v_dot2c_f32_bf16 v101, s92, v41
    v_dot2c_f32_bf16 v100, s92, v42
    v_dot2c_f32_bf16 v101, s92, v43
    s_waitcnt lgkmcnt(0)
    v_dot2c_f32_bf16 v100, s92, v44
    v_dot2c_f32_bf16 v101, s92, v45
    v_dot2c_f32_bf16 v100, s92, v46
    v_dot2c_f32_bf16 v101, s92, v47
LA_pr0f:
    s_load_dword s40, s[36:37], 2044 glc
    s_load_dword s41, s[36:37], 4092 glc
    s_load_dword s42, s[36:37], 6140 glc
    s_load_dword s43, s[36:37], 8188 glc
    s_sub_u32 s27, s27, 1
    s_cselect_b32 s27, 0, s27
    s_cselect_b32 s44, 0, 0xffff0000
    s_waitcnt lgkmcnt(0)
    s_xor_b64 s[46:47], s[40:41], s[32:33]
    s_xor_b64 s[38:39], s[42:43], s[32:33]
    s_or_b64 s[46:47], s[46:47], s[38:39]
    s_or_b32 s46, s46, s47
    s_and_b32 s46, s46, s44
    s_cbranch_scc1 LA_pr0f
    s_add_u32 m0, s30, 114688
    s_nop 0
    buffer_load_dwordx4 v1, s[12:15], s29 offen offset:0 sc1 lds
    buffer_load_dwordx4 v1, s[12:15], s29 offen offset:1024 sc1 lds
    buffer_load_dwordx4 v1, s[12:15], s29 offen offset:2048 sc1 lds
    buffer_load_dwordx4 v1, s[12:15], s29 offen offset:3072 sc1 lds
    s_add_u32 m0, s30, 118784
    s_sub_u32 s27, s27, 1
    buffer_load_dwordx4 v1, s[12:15], s31 offen offset:0 sc1 lds
    buffer_load_dwordx4 v1, s[12:15], s31 offen offset:1024 sc1 lds
    buffer_load_dwordx4 v1, s[12:15], s31 offen offset:2048 sc1 lds
    buffer_load_dwordx4 v1, s[12:15], s31 offen offset:3072 sc1 lds
    ds_read_b64_tr_b16 v[48:49], v98 offset:32768
    ds_read_b64_tr_b16 v[50:51], v98 offset:34816
    ds_read_b64_tr_b16 v[52:53], v98 offset:36864
    ds_read_b64_tr_b16 v[54:55], v98 offset:38912
    ds_read_b64_tr_b16 v[56:57], v98 offset:40960
    ds_read_b64_tr_b16 v[58:59], v98 offset:43008
    ds_read_b64_tr_b16 v[60:61], v98 offset:45056
    ds_read_b64_tr_b16 v[62:63], v98 offset:47104
    ds_read_b64_tr_b16 v[40:41], v98 offset:49152
    ds_read_b64_tr_b16 v[42:43], v98 offset:51200
    ds_read_b64_tr_b16 v[44:45], v98 offset:53248
    ds_read_b64_tr_b16 v[46:47], v98 offset:55296
    s_waitcnt lgkmcnt(10)
    v_dot2c_f32_bf16 v100, s92, v48
    v_dot2c_f32_bf16 v101, s92, v49
    v_dot2c_f32_bf16 v100, s92, v50
    v_dot2c_f32_bf16 v101, s92, v51
    ds_read_b64_tr_b16 v[48:49], v98 offset:57344
    ds_read_b64_tr_b16 v[50:51], v98 offset:59392
    s_waitcnt lgkmcnt(10)
    v_dot2c_f32_bf16 v100, s92, v52
    v_dot2c_f32_bf16 v101, s92, v53
    v_dot2c_f32_bf16 v100, s92, v54
    v_dot2c_f32_bf16 v101, s92, v55
    ds_read_b64_tr_b16 v[52:53], v98 offset:61440
    ds_read_b64_tr_b16 v[54:55], v98 offset:63488
    s_waitcnt lgkmcnt(10)
    v_dot2c_f32_bf16 v100, s92, v56
    v_dot2c_f32_bf16 v101, s92, v57
    v_dot2c_f32_bf16 v100, s92, v58
    v_dot2c_f32_bf16 v101, s92, v59
    ds_read_b64_tr_b16 v[56:57], v99 offset:0
    ds_read_b64_tr_b16 v[58:59], v99 offset:2048
    s_waitcnt lgkmcnt(10)
    v_dot2c_f32_bf16 v100, s92, v60
    v_dot2c_f32_bf16 v101, s92, v61
    v_dot2c_f32_bf16 v100, s92, v62
    v_dot2c_f32_bf16 v101, s92, v63
    ds_read_b64_tr_b16 v[60:61], v99 offset:4096
    ds_read_b64_tr_b16 v[62:63], v99 offset:6144
    s_waitcnt lgkmcnt(10)
    v_dot2c_f32_bf16 v100, s92, v40
    v_dot2c_f32_bf16 v101, s92, v41
    v_dot2c_f32_bf16 v100, s92, v42
    v_dot2c_f32_bf16 v101, s92, v43
    ds_read_b64_tr_b16 v[40:41], v99 offset:8192
    ds_read_b64_tr_b16 v[42:43], v99 offset:10240
    s_waitcnt lgkmcnt(10)
    v_dot2c_f32_bf16 v100, s92, v44
    v_dot2c_f32_bf16 v101, s92, v45
    v_dot2c_f32_bf16 v100, s92, v46
    v_dot2c_f32_bf16 v101, s92, v47
    ds_read_b64_tr_b16 v[44:45], v99 offset:12288
    ds_read_b64_tr_b16 v[46:47], v99 offset:14336
    s_waitcnt lgkmcnt(10)
    v_dot2c_f32_bf16 v100, s92, v48
    v_dot2c_f32_bf16 v101, s92, v49
    v_dot2c_f32_bf16 v100, s92, v50
    v_dot2c_f32_bf16 v101, s92, v51
    s_waitcnt lgkmcnt(8)
    v_dot2c_f32_bf16 v100, s92, v52
    v_dot2c_f32_bf16 v101, s92, v53
    v_dot2c_f32_bf16 v100, s92, v54
    v_dot2c_f32_bf16 v101, s92, v55
    s_waitcnt lgkmcnt(6)
    v_dot2c_f32_bf16 v100, s92, v56
    v_dot2c_f32_bf16 v101, s92, v57
    v_dot2c_f32_bf16 v100, s92, v58
    v_dot2c_f32_bf16 v101, s92, v59
    s_waitcnt lgkmcnt(4)
    v_dot2c_f32_bf16 v100, s92, v60
    v_dot2c_f32_bf16 v101, s92, v61
    v_dot2c_f32_bf16 v100, s92, v62
    v_dot2c_f32_bf16 v101, s92, v63
    s_waitcnt lgkmcnt(2)
    v_dot2c_f32_bf16 v100, s92, v40
    v_dot2c_f32_bf16 v101, s92, v41
    v_dot2c_f32_bf16 v100, s92, v42
    v_dot2c_f32_bf16 v101, s92, v43
    s_waitcnt lgkmcnt(0)
    v_dot2c_f32_bf16 v100, s92, v44
    v_dot2c_f32_bf16 v101, s92, v45
    v_dot2c_f32_bf16 v100, s92, v46
    v_dot2c_f32_bf16 v101, s92, v47
LA_vf:
    s_waitcnt vmcnt(4)
    ds_read_b32 v64, v7 offset:12
    ds_read_b32 v65, v7 offset:1036
    ds_read_b32 v66, v7 offset:2060
    ds_read_b32 v67, v7 offset:3084
    s_waitcnt vmcnt(0)
    ds_read_b32 v68, v7 offset:4108
    ds_read_b32 v69, v7 offset:5132
    ds_read_b32 v70, v7 offset:6156
    ds_read_b32 v71, v7 offset:7180
    s_waitcnt lgkmcnt(7)
    v_xor_b32 v8, v64, v5
    s_waitcnt lgkmcnt(6)
    v_bitop3_b32 v8, v65, v5, v8 bitop3:0xbe
    s_waitcnt lgkmcnt(5)
    v_bitop3_b32 v8, v66, v5, v8 bitop3:0xbe
    s_waitcnt lgkmcnt(4)
    v_bitop3_b32 v8, v67, v5, v8 bitop3:0xbe
    s_waitcnt lgkmcnt(3)
    v_bitop3_b32 v8, v68, v5, v8 bitop3:0xbe
    s_waitcnt lgkmcnt(2)
    v_bitop3_b32 v8, v69, v5, v8 bitop3:0xbe
    s_waitcnt lgkmcnt(1)
    v_bitop3_b32 v8, v70, v5, v8 bitop3:0xbe
    s_waitcnt lgkmcnt(0)
    v_bitop3_b32 v8, v71, v5, v8 bitop3:0xbe
    v_cmp_lt_u32 vcc, 0xffff, v8
    s_cbranch_scc1 LA_gx
    s_cbranch_vccnz LA_pr0
LA_gd:
    s_cmp_ge_u32 s73, 14
    s_barrier
    s_cbranch_scc1 LA_p3d
    ds_read_b128 v[32:35], v3 offset:0
    ds_read_b128 v[36:39], v3 offset:1024
    ds_read_b128 v[40:43], v3 offset:2048
    ds_read_b128 v[44:47], v3 offset:3072
    ds_read_b128 v[48:51], v3 offset:4096
    ds_read_b128 v[52:55], v3 offset:5120
    ds_read_b128 v[56:59], v3 offset:6144
    s_waitcnt lgkmcnt(6)
    v_mfma_f32_32x32x16_bf16 v[16:31], v[128:131], v[32:35], v[16:31]
    ds_read_b128 v[60:63], v3 offset:7168
    buffer_load_dwordx4 v[252:255], v1, s[12:15], s70 offen offset:3072 sc1
    s_add_u32 s70, s70, 4096
    s_waitcnt lgkmcnt(6)
    v_mfma_f32_32x32x16_bf16 v[16:31], v[132:135], v[36:39], v[16:31]
    ds_read_b128 v[32:35], v3 offset:8192
    s_waitcnt lgkmcnt(6)
    v_mfma_f32_32x32x16_bf16 v[16:31], v[136:139], v[40:43], v[16:31]
    ds_read_b128 v[36:39], v3 offset:9216
    s_waitcnt lgkmcnt(6)
    v_mfma_f32_32x32x16_bf16 v[16:31], v[140:143], v[44:47], v[16:31]
    ds_read_b128 v[40:43], v3 offset:10240
    s_waitcnt lgkmcnt(6)
    v_mfma_f32_32x32x16_bf16 v[16:31], v[144:147], v[48:51], v[16:31]
    ds_read_b128 v[44:47], v3 offset:11264
    s_waitcnt lgkmcnt(6)
    v_mfma_f32_32x32x16_bf16 v[16:31], v[148:151], v[52:55], v[16:31]
    ds_read_b128 v[48:51], v3 offset:12288
    s_waitcnt lgkmcnt(6)
    v_mfma_f32_32x32x16_bf16 v[16:31], v[152:155], v[56:59], v[16:31]
    ds_read_b128 v[52:55], v3 offset:13312
    s_waitcnt lgkmcnt(6)
    v_mfma_f32_32x32x16_bf16 v[16:31], v[156:159], v[60:63], v[16:31]
    ds_read_b128 v[56:59], v3 offset:14336
    s_waitcnt lgkmcnt(6)
    v_mfma_f32_32x32x16_bf16 v[16:31], v[160:163], v[32:35], v[16:31]
    ds_read_b128 v[60:63], v3 offset:15360
    s_waitcnt lgkmcnt(6)
    v_mfma_f32_32x32x16_bf16 v[16:31], v[164:167], v[36:39], v[16:31]
    ds_read_b128 v[32:35], v3 offset:16384
    s_waitcnt lgkmcnt(6)
    v_mfma_f32_32x32x16_bf16 v[16:31], v[168:171], v[40:43], v[16:31]
    ds_read_b128 v[36:39], v3 offset:17408
    s_waitcnt lgkmcnt(6)
    v_mfma_f32_32x32x16_bf16 v[16:31], v[172:175], v[44:47], v[16:31]
    ds_read_b128 v[40:43], v3 offset:18432
    s_waitcnt lgkmcnt(6)
    v_mfma_f32_32x32x16_bf16 v[16:31], v[176:179], v[48:51], v[16:31]
    ds_read_b128 v[44:47], v3 offset:19456
    s_waitcnt lgkmcnt(6)
    v_mfma_f32_32x32x16_bf16 v[16:31], v[180:183], v[52:55], v[16:31]
    ds_read_b128 v[48:51], v3 offset:20480
    s_waitcnt lgkmcnt(6)
    v_mfma_f32_32x32x16_bf16 v[16:31], v[184:187], v[56:59], v[16:31]
    ds_read_b128 v[52:55], v3 offset:21504
    s_waitcnt lgkmcnt(6)
    v_mfma_f32_32x32x16_bf16 v[16:31], v[188:191], v[60:63], v[16:31]
    ds_read_b128 v[56:59], v3 offset:22528
    s_waitcnt lgkmcnt(6)
    v_mfma_f32_32x32x16_bf16 v[16:31], v[192:195], v[32:35], v[16:31]
    ds_read_b128 v[60:63], v3 offset:23552
    s_waitcnt lgkmcnt(6)
    v_mfma_f32_32x32x16_bf16 v[16:31], v[196:199], v[36:39], v[16:31]
    ds_read_b128 v[32:35], v3 offset:24576
    s_waitcnt lgkmcnt(6)
    v_mfma_f32_32x32x16_bf16 v[16:31], v[200:203], v[40:43], v[16:31]
    ds_read_b128 v[36:39], v3 offset:25600
    s_waitcnt lgkmcnt(6)
    v_mfma_f32_32x32x16_bf16 v[16:31], v[204:207], v[44:47], v[16:31]
    ds_read_b128 v[40:43], v3 offset:26624
    s_waitcnt lgkmcnt(6)
    v_mfma_f32_32x32x16_bf16 v[16:31], v[208:211], v[48:51], v[16:31]
    ds_read_b128 v[44:47], v3 offset:27648
    s_waitcnt lgkmcnt(6)
    v_mfma_f32_32x32x16_bf16 v[16:31], v[212:215], v[52:55], v[16:31]
    ds_read_b128 v[48:51], v3 offset:28672
    s_waitcnt lgkmcnt(6)
    v_mfma_f32_32x32x16_bf16 v[16:31], v[216:219], v[56:59], v[16:31]
    ds_read_b128 v[52:55], v3 offset:29696
    s_waitcnt lgkmcnt(6)
    v_mfma_f32_32x32x16_bf16 v[16:31], v[220:223], v[60:63], v[16:31]
    ds_read_b128 v[56:59], v3 offset:30720
    s_waitcnt lgkmcnt(6)
    v_mfma_f32_32x32x16_bf16 v[16:31], v[224:227], v[32:35], v[16:31]
    ds_read_b128 v[60:63], v3 offset:31744
    s_waitcnt lgkmcnt(6)
    v_mfma_f32_32x32x16_bf16 v[16:31], v[228:231], v[36:39], v[16:31]
    s_waitcnt lgkmcnt(5)
    v_mfma_f32_32x32x16_bf16 v[16:31], v[232:235], v[40:43], v[16:31]
    s_waitcnt lgkmcnt(4)
    v_mfma_f32_32x32x16_bf16 v[16:31], v[236:239], v[44:47], v[16:31]
    s_waitcnt lgkmcnt(3)
    v_mfma_f32_32x32x16_bf16 v[16:31], v[240:243], v[48:51], v[16:31]
    s_waitcnt lgkmcnt(2)
    v_mfma_f32_32x32x16_bf16 v[16:31], v[244:247], v[52:55], v[16:31]
    s_waitcnt lgkmcnt(1)
    v_mfma_f32_32x32x16_bf16 v[16:31], v[248:251], v[56:59], v[16:31]
    s_waitcnt vmcnt(0) lgkmcnt(0)
    v_mfma_f32_32x32x16_bf16 v[16:31], v[252:255], v[60:63], v[16:31]
    s_nop 11
    v_cvt_pk_bf16_f32 v32, v16, v17
    v_cvt_pk_bf16_f32 v33, v18, v19
    v_cvt_pk_bf16_f32 v34, v20, v21
    v_cvt_pk_bf16_f32 v35, v22, v23
    buffer_store_dwordx4 v[32:35], v1, s[12:15], s57 offen offset:0
    v_cvt_pk_bf16_f32 v36, v24, v25
    v_cvt_pk_bf16_f32 v37, v26, v27
    v_cvt_pk_bf16_f32 v38, v28, v29
    v_cvt_pk_bf16_f32 v39, v30, v31
    buffer_store_dwordx4 v[36:39], v1, s[12:15], s57 offen offset:1024
    v_pk_add_f32 v[8:9], v[16:17], v[18:19]
    v_pk_mul_f32 v[10:11], v[16:17], v[16:17]
    v_pk_fma_f32 v[10:11], v[18:19], v[18:19], v[10:11]
    v_pk_add_f32 v[8:9], v[8:9], v[20:21]
    v_pk_fma_f32 v[10:11], v[20:21], v[20:21], v[10:11]
    v_pk_add_f32 v[8:9], v[8:9], v[22:23]
    v_pk_fma_f32 v[10:11], v[22:23], v[22:23], v[10:11]
    v_pk_add_f32 v[8:9], v[8:9], v[24:25]
    v_pk_fma_f32 v[10:11], v[24:25], v[24:25], v[10:11]
    v_pk_add_f32 v[8:9], v[8:9], v[26:27]
    v_pk_fma_f32 v[10:11], v[26:27], v[26:27], v[10:11]
    v_pk_add_f32 v[8:9], v[8:9], v[28:29]
    v_pk_fma_f32 v[10:11], v[28:29], v[28:29], v[10:11]
    v_pk_add_f32 v[8:9], v[8:9], v[30:31]
    v_pk_fma_f32 v[10:11], v[30:31], v[30:31], v[10:11]
    v_add_f32 v8, v8, v9
    v_add_f32 v9, v10, v11
    s_nop 1
    v_permlane32_swap_b32 v8, v9
    v_add_f32 v8, v8, v9
    buffer_store_dword v8, v1, s[12:15], s58 offen
LA_p3d:
    s_cmp_lt_u32 s73, 14
    s_cselect_b32 s61, s59, 1073741824
    ds_read_b64_tr_b16 v[48:49], v99 offset:16384
    ds_read_b64_tr_b16 v[50:51], v99 offset:18432
    ds_read_b64_tr_b16 v[52:53], v99 offset:20480
    ds_read_b64_tr_b16 v[54:55], v99 offset:22528
    ds_read_b64_tr_b16 v[56:57], v99 offset:24576
    ds_read_b64_tr_b16 v[58:59], v99 offset:26624
    ds_read_b64_tr_b16 v[60:61], v99 offset:28672
    ds_read_b64_tr_b16 v[62:63], v99 offset:30720
    ds_read_b64_tr_b16 v[40:41], v99 offset:32768
    ds_read_b64_tr_b16 v[42:43], v99 offset:34816
    ds_read_b64_tr_b16 v[44:45], v99 offset:36864
    ds_read_b64_tr_b16 v[46:47], v99 offset:38912
    s_waitcnt lgkmcnt(10)
    v_dot2c_f32_bf16 v100, s92, v48
    v_dot2c_f32_bf16 v101, s92, v49
    v_dot2c_f32_bf16 v100, s92, v50
    v_dot2c_f32_bf16 v101, s92, v51
    ds_read_b64_tr_b16 v[48:49], v99 offset:40960
    ds_read_b64_tr_b16 v[50:51], v99 offset:43008
    s_waitcnt lgkmcnt(10)
    v_dot2c_f32_bf16 v100, s92, v52
    v_dot2c_f32_bf16 v101, s92, v53
    v_dot2c_f32_bf16 v100, s92, v54
    v_dot2c_f32_bf16 v101, s92, v55
    ds_read_b64_tr_b16 v[52:53], v99 offset:45056
    ds_read_b64_tr_b16 v[54:55], v99 offset:47104
    s_waitcnt lgkmcnt(10)
    v_dot2c_f32_bf16 v100, s92, v56
    v_dot2c_f32_bf16 v101, s92, v57
    v_dot2c_f32_bf16 v100, s92, v58
    v_dot2c_f32_bf16 v101, s92, v59
    s_waitcnt lgkmcnt(8)
    v_dot2c_f32_bf16 v100, s92, v60
    v_dot2c_f32_bf16 v101, s92, v61
    v_dot2c_f32_bf16 v100, s92, v62
    v_dot2c_f32_bf16 v101, s92, v63
    s_waitcnt lgkmcnt(6)
    v_dot2c_f32_bf16 v100, s92, v40
    v_dot2c_f32_bf16 v101, s92, v41
    v_dot2c_f32_bf16 v100, s92, v42
    v_dot2c_f32_bf16 v101, s92, v43
    s_waitcnt lgkmcnt(4)
    v_dot2c_f32_bf16 v100, s92, v44
    v_dot2c_f32_bf16 v101, s92, v45
    v_dot2c_f32_bf16 v100, s92, v46
    v_dot2c_f32_bf16 v101, s92, v47
    s_waitcnt lgkmcnt(2)
    v_dot2c_f32_bf16 v100, s92, v48
    v_dot2c_f32_bf16 v101, s92, v49
    v_dot2c_f32_bf16 v100, s92, v50
    v_dot2c_f32_bf16 v101, s92, v51
    s_waitcnt lgkmcnt(0)
    v_dot2c_f32_bf16 v100, s92, v52
    v_dot2c_f32_bf16 v101, s92, v53
    v_dot2c_f32_bf16 v100, s92, v54
    v_dot2c_f32_bf16 v101, s92, v55
    v_lshlrev_b32 v7, 16, v97
    v_mov_b32 v10, 0
    v_mov_b32 v11, 0
    v_add_f32 v4, v100, v101
    v_cvt_pk_bf16_f32 v5, v4, v4
    v_and_b32 v5, 0xffff0000, v5
    v_sub_f32 v5, v4, v5
    v_cvt_pk_bf16_f32 v8, v4, v5
    v_cvt_pk_bf16_f32 v9, v4, v7
    s_lshl_b32 s28, s68, 10
    s_add_u32 s28, s28, 155648
    v_add_u32 v4, s28, v1
    ds_write_b128 v4, v[8:11]
    v_mov_b32 v5, s25
    s_cmp_lg_u32 s26, 0
    s_waitcnt vmcnt(0)
    buffer_store_dword v5, v2, s[12:15], s61 offen
    s_cbranch_scc1 Lpubg_3
Lpubd_4:
    s_cmp_ge_u32 s5, 28
    s_cbranch_scc1 LA_idle
    s_lshl_b32 s28, s74, 7
    s_add_u32 s28, s28, 16384
    v_min_u32 v4, 13, v0
    v_lshlrev_b32 v4, 2, v4
    s_mul_i32 s29, s74, 28672
    s_add_u32 s29, s29, 3670016
    s_lshl_b32 s30, s74, 12
    s_add_u32 s30, s30, 3407872
    s_and_b32 s31, s74, 7
    s_mul_i32 s31, s31, 14
    s_add_u32 s31, s31, s75
    s_mul_i32 s31, s31, 6144
    s_lshl_b32 s60, s75, 11
    s_add_u32 s60, s60, s29
    s_sub_u32 s60, s60, 2048
    s_add_u32 s59, s31, s99
    s_add_u32 s31, s59, 4096
    s_lshl_b32 s32, s74, 5
    s_add_u32 s32, s32, s75
    s_lshl_b32 s32, s32, 2
    s_add_u32 s32, s32, 24576
    v_add_u32 v7, 131072, v1
    v_bfe_u32 v8, v0, 2, 2
    v_lshrrev_b32 v9, 5, v0
    v_lshl_add_u32 v9, v9, 2, v8
    v_lshlrev_b32 v9, 8, v9
    v_bfe_u32 v10, v0, 4, 1
    v_lshl_add_u32 v9, v10, 5, v9
    v_and_b32 v10, 3, v0
    v_lshl_add_u32 v9, v10, 3, v9
    v_lshrrev_b32 v10, 5, v0
    v_lshlrev_b32 v10, 4, v10
    v_xor_b32 v9, v9, v10
    v_xor_b32 v10, 0, v8
    v_lshl_add_u32 v244, v10, 6, v9
    v_add_u32 v245, 65536, v244
    v_xor_b32 v10, 1, v8
    v_lshl_add_u32 v246, v10, 6, v9
    v_add_u32 v247, 65536, v246
    v_xor_b32 v10, 2, v8
    v_lshl_add_u32 v248, v10, 6, v9
    v_add_u32 v249, 65536, v248
    v_xor_b32 v10, 3, v8
    v_lshl_add_u32 v250, v10, 6, v9
    v_add_u32 v251, 65536, v250
    s_mov_b32 s16, s50
    s_mov_b32 s17, s51
    s_mov_b32 s18, 896
    s_mov_b32 s19, 0x20000
    s_mov_b32 s20, s52
    s_mov_b32 s21, s53
    s_mov_b32 s22, 1835008
    s_mov_b32 s23, 0x20000
    v_lshrrev_b32 v13, 3, v0
    s_lshl_b32 s33, s3, 3
    v_add_u32 v13, s33, v13
    v_and_b32 v14, 7, v0
    v_lshlrev_b32 v14, 4, v14
    s_lshl_b32 s58, s77, 7
    s_mul_i32 s56, s76, 7
    s_add_u32 s56, s56, s77
    s_lshl_b32 s56, s56, 12
    s_add_u32 s56, s56, 3670016
    s_add_u32 s57, s56, 28672
    ds_read_b64_tr_b16 v[80:81], v244 offset:0
    ds_read_b64_tr_b16 v[82:83], v244 offset:2048
    ds_read_b64_tr_b16 v[84:85], v246 offset:0
    ds_read_b64_tr_b16 v[86:87], v246 offset:2048
    ds_read_b64_tr_b16 v[88:89], v248 offset:0
    ds_read_b64_tr_b16 v[90:91], v248 offset:2048
    ds_read_b64_tr_b16 v[92:93], v244 offset:4096
    ds_read_b64_tr_b16 v[94:95], v244 offset:6144
    ds_read_b64_tr_b16 v[112:113], v246 offset:4096
    ds_read_b64_tr_b16 v[114:115], v246 offset:6144
    ds_read_b64_tr_b16 v[116:117], v248 offset:4096
    ds_read_b64_tr_b16 v[118:119], v248 offset:6144
    ds_read_b64_tr_b16 v[120:121], v244 offset:8192
    ds_read_b64_tr_b16 v[122:123], v244 offset:10240
    s_cmp_lg_u32 s26, 0
    s_cbranch_scc1 Lpollg_6
Lpoll_5:
    buffer_load_dword v5, v4, s[12:15], s28 offen sc1
    s_sub_u32 s27, s27, 1
    s_waitcnt vmcnt(0)
    v_cmp_ne_u32 vcc, s25, v5
    s_cbranch_scc1 Lpollr_8
    s_cbranch_vccnz Lpoll_5
Lpolld_7:
    buffer_load_dwordx4 v[128:131], v1, s[12:15], s29 offen offset:0 sc1
    buffer_load_dwordx4 v[132:135], v1, s[12:15], s29 offen offset:1024 sc1
    buffer_load_dwordx4 v[136:139], v1, s[12:15], s29 offen offset:2048 sc1
    buffer_load_dwordx4 v[140:143], v1, s[12:15], s29 offen offset:3072 sc1
    s_add_u32 s29, s29, 4096
    buffer_load_dwordx4 v[144:147], v1, s[12:15], s29 offen offset:0 sc1
    buffer_load_dwordx4 v[148:151], v1, s[12:15], s29 offen offset:1024 sc1
    buffer_load_dwordx4 v[152:155], v1, s[12:15], s29 offen offset:2048 sc1
    s_waitcnt vmcnt(6) lgkmcnt(10)
    v_mfma_f32_32x32x16_bf16 v[16:31], v[80:83], v[128:131], 0
    ds_read_b64_tr_b16 v[124:125], v246 offset:8192
    ds_read_b64_tr_b16 v[126:127], v246 offset:10240
    v_mfma_f32_32x32x16_bf16 v[32:47], v[84:87], v[128:131], 0
    buffer_load_dwordx4 v[156:159], v1, s[12:15], s29 offen offset:3072 sc1
    s_add_u32 s29, s29, 4096
    ds_read_b64_tr_b16 v[80:81], v248 offset:8192
    ds_read_b64_tr_b16 v[82:83], v248 offset:10240
    s_waitcnt lgkmcnt(10)
    v_mfma_f32_32x32x16_bf16 v[48:63], v[88:91], v[128:131], 0
    ds_read_b64_tr_b16 v[84:85], v244 offset:12288
    ds_read_b64_tr_b16 v[86:87], v244 offset:14336
    s_waitcnt vmcnt(6)
    v_mfma_f32_32x32x16_bf16 v[16:31], v[92:95], v[132:135], v[16:31]
    buffer_load_dwordx4 v[160:163], v1, s[12:15], s29 offen offset:0 sc1
    ds_read_b64_tr_b16 v[88:89], v246 offset:12288
    ds_read_b64_tr_b16 v[90:91], v246 offset:14336
    s_waitcnt lgkmcnt(10)
    v_mfma_f32_32x32x16_bf16 v[32:47], v[112:115], v[132:135], v[32:47]
    ds_read_b64_tr_b16 v[92:93], v248 offset:12288
    ds_read_b64_tr_b16 v[94:95], v248 offset:14336
    v_mfma_f32_32x32x16_bf16 v[48:63], v[116:119], v[132:135], v[48:63]
    buffer_load_dwordx4 v[164:167], v1, s[12:15], s29 offen offset:1024 sc1
    ds_read_b64_tr_b16 v[112:113], v244 offset:16384
    ds_read_b64_tr_b16 v[114:115], v244 offset:18432
    s_waitcnt vmcnt(7) lgkmcnt(10)
    v_mfma_f32_32x32x16_bf16 v[16:31], v[120:123], v[136:139], v[16:31]
    ds_read_b64_tr_b16 v[116:117], v246 offset:16384
    ds_read_b64_tr_b16 v[118:119], v246 offset:18432
    v_mfma_f32_32x32x16_bf16 v[32:47], v[124:127], v[136:139], v[32:47]
    buffer_load_dwordx4 v[168:171], v1, s[12:15], s29 offen offset:2048 sc1
    ds_read_b64_tr_b16 v[120:121], v248 offset:16384
    ds_read_b64_tr_b16 v[122:123], v248 offset:18432
    s_waitcnt lgkmcnt(10)
    v_mfma_f32_32x32x16_bf16 v[48:63], v[80:83], v[136:139], v[48:63]
    ds_read_b64_tr_b16 v[124:125], v244 offset:20480
    ds_read_b64_tr_b16 v[126:127], v244 offset:22528
    s_waitcnt vmcnt(7)
    v_mfma_f32_32x32x16_bf16 v[16:31], v[84:87], v[140:143], v[16:31]
    buffer_load_dwordx4 v[172:175], v1, s[12:15], s29 offen offset:3072 sc1
    s_add_u32 s29, s29, 4096
    ds_read_b64_tr_b16 v[80:81], v246 offset:20480
    ds_read_b64_tr_b16 v[82:83], v246 offset:22528
    s_waitcnt lgkmcnt(10)
    v_mfma_f32_32x32x16_bf16 v[32:47], v[88:91], v[140:143], v[32:47]
    ds_read_b64_tr_b16 v[84:85], v248 offset:20480
    ds_read_b64_tr_b16 v[86:87], v248 offset:22528
    v_mfma_f32_32x32x16_bf16 v[48:63], v[92:95], v[140:143], v[48:63]
    buffer_load_dwordx4 v[96:99], v1, s[12:15], s30 offen offset:0 sc1
    ds_read_b64_tr_b16 v[88:89], v244 offset:24576
    ds_read_b64_tr_b16 v[90:91], v244 offset:26624
    s_waitcnt vmcnt(8) lgkmcnt(10)
    v_mfma_f32_32x32x16_bf16 v[16:31], v[112:115], v[144:147], v[16:31]
    ds_read_b64_tr_b16 v[92:93], v246 offset:24576
    ds_read_b64_tr_b16 v[94:95], v246 offset:26624
    v_mfma_f32_32x32x16_bf16 v[32:47], v[116:119], v[144:147], v[32:47]
    buffer_load_dwordx4 v[176:179], v1, s[12:15], s29 offen offset:0 sc1
    ds_read_b64_tr_b16 v[112:113], v248 offset:24576
    ds_read_b64_tr_b16 v[114:115], v248 offset:26624
    s_waitcnt lgkmcnt(10)
    v_mfma_f32_32x32x16_bf16 v[48:63], v[120:123], v[144:147], v[48:63]
    ds_read_b64_tr_b16 v[116:117], v244 offset:28672
    ds_read_b64_tr_b16 v[118:119], v244 offset:30720
    s_waitcnt vmcnt(8)
    v_mfma_f32_32x32x16_bf16 v[16:31], v[124:127], v[148:151], v[16:31]
    buffer_load_dwordx4 v[180:183], v1, s[12:15], s29 offen offset:1024 sc1
    ds_read_b64_tr_b16 v[120:121], v246 offset:28672
    ds_read_b64_tr_b16 v[122:123], v246 offset:30720
    s_waitcnt lgkmcnt(10)
    v_mfma_f32_32x32x16_bf16 v[32:47], v[80:83], v[148:151], v[32:47]
    ds_read_b64_tr_b16 v[124:125], v248 offset:28672
    ds_read_b64_tr_b16 v[126:127], v248 offset:30720
    v_mfma_f32_32x32x16_bf16 v[48:63], v[84:87], v[148:151], v[48:63]
    buffer_load_dwordx4 v[100:103], v1, s[12:15], s30 offen offset:1024 sc1
    ds_read_b64_tr_b16 v[80:81], v244 offset:32768
    ds_read_b64_tr_b16 v[82:83], v244 offset:34816
    s_waitcnt vmcnt(9) lgkmcnt(10)
    v_mfma_f32_32x32x16_bf16 v[16:31], v[88:91], v[152:155], v[16:31]
    ds_read_b64_tr_b16 v[84:85], v246 offset:32768
    ds_read_b64_tr_b16 v[86:87], v246 offset:34816
    v_mfma_f32_32x32x16_bf16 v[32:47], v[92:95], v[152:155], v[32:47]
    buffer_load_dwordx4 v[184:187], v1, s[12:15], s29 offen offset:2048 sc1
    ds_read_b64_tr_b16 v[88:89], v248 offset:32768
    ds_read_b64_tr_b16 v[90:91], v248 offset:34816
    s_waitcnt lgkmcnt(10)
    v_mfma_f32_32x32x16_bf16 v[48:63], v[112:115], v[152:155], v[48:63]
    ds_read_b64_tr_b16 v[92:93], v244 offset:36864
    ds_read_b64_tr_b16 v[94:95], v244 offset:38912
    s_waitcnt vmcnt(9)
    v_mfma_f32_32x32x16_bf16 v[16:31], v[116:119], v[156:159], v[16:31]
    buffer_load_dwordx4 v[188:191], v1, s[12:15], s29 offen offset:3072 sc1
    s_add_u32 s29, s29, 4096
    ds_read_b64_tr_b16 v[112:113], v246 offset:36864
    ds_read_b64_tr_b16 v[114:115], v246 offset:38912
    s_waitcnt lgkmcnt(10)
    v_mfma_f32_32x32x16_bf16 v[32:47], v[120:123], v[156:159], v[32:47]
    ds_read_b64_tr_b16 v[116:117], v248 offset:36864
    ds_read_b64_tr_b16 v[118:119], v248 offset:38912
    v_mfma_f32_32x32x16_bf16 v[48:63], v[124:127], v[156:159], v[48:63]
    buffer_load_dwordx4 v[104:107], v1, s[12:15], s30 offen offset:2048 sc1
    ds_read_b64_tr_b16 v[120:121], v244 offset:40960
    ds_read_b64_tr_b16 v[122:123], v244 offset:43008
    s_waitcnt vmcnt(10) lgkmcnt(10)
    v_mfma_f32_32x32x16_bf16 v[16:31], v[80:83], v[160:163], v[16:31]
    ds_read_b64_tr_b16 v[124:125], v246 offset:40960
    ds_read_b64_tr_b16 v[126:127], v246 offset:43008
    v_mfma_f32_32x32x16_bf16 v[32:47], v[84:87], v[160:163], v[32:47]
    buffer_load_dwordx4 v[192:195], v1, s[12:15], s29 offen offset:0 sc1
    ds_read_b64_tr_b16 v[80:81], v248 offset:40960
    ds_read_b64_tr_b16 v[82:83], v248 offset:43008
    s_waitcnt lgkmcnt(10)
    v_mfma_f32_32x32x16_bf16 v[48:63], v[88:91], v[160:163], v[48:63]
    ds_read_b64_tr_b16 v[84:85], v244 offset:45056
    ds_read_b64_tr_b16 v[86:87], v244 offset:47104
    s_waitcnt vmcnt(10)
    v_mfma_f32_32x32x16_bf16 v[16:31], v[92:95], v[164:167], v[16:31]
    buffer_load_dwordx4 v[196:199], v1, s[12:15], s29 offen offset:1024 sc1
    ds_read_b64_tr_b16 v[88:89], v246 offset:45056
    ds_read_b64_tr_b16 v[90:91], v246 offset:47104
    s_waitcnt lgkmcnt(10)
    v_mfma_f32_32x32x16_bf16 v[32:47], v[112:115], v[164:167], v[32:47]
    ds_read_b64_tr_b16 v[92:93], v248 offset:45056
    ds_read_b64_tr_b16 v[94:95], v248 offset:47104
    v_mfma_f32_32x32x16_bf16 v[48:63], v[116:119], v[164:167], v[48:63]
    buffer_load_dwordx2 v[108:109], v1, s[12:15], s30 offen offset:3072 sc1
    ds_read_b64_tr_b16 v[112:113], v244 offset:49152
    ds_read_b64_tr_b16 v[114:115], v244 offset:51200
    s_waitcnt vmcnt(11) lgkmcnt(10)
    v_mfma_f32_32x32x16_bf16 v[16:31], v[120:123], v[168:171], v[16:31]
    ds_read_b64_tr_b16 v[116:117], v246 offset:49152
    ds_read_b64_tr_b16 v[118:119], v246 offset:51200
    v_mfma_f32_32x32x16_bf16 v[32:47], v[124:127], v[168:171], v[32:47]
    buffer_load_dwordx4 v[200:203], v1, s[12:15], s29 offen offset:2048 sc1
    ds_read_b64_tr_b16 v[120:121], v244 offset:53248
    ds_read_b64_tr_b16 v[122:123], v244 offset:55296
    s_waitcnt lgkmcnt(10)
    v_mfma_f32_32x32x16_bf16 v[48:63], v[80:83], v[168:171], v[48:63]
    ds_read_b64_tr_b16 v[124:125], v246 offset:53248
    ds_read_b64_tr_b16 v[126:127], v246 offset:55296
    s_waitcnt vmcnt(11)
    v_mfma_f32_32x32x16_bf16 v[16:31], v[84:87], v[172:175], v[16:31]
    buffer_load_dwordx4 v[204:207], v1, s[12:15], s29 offen offset:3072 sc1
    s_add_u32 s29, s29, 4096
    ds_read_b64_tr_b16 v[80:81], v244 offset:57344
    ds_read_b64_tr_b16 v[82:83], v244 offset:59392
    s_waitcnt lgkmcnt(10)
    v_mfma_f32_32x32x16_bf16 v[32:47], v[88:91], v[172:175], v[32:47]
    ds_read_b64_tr_b16 v[84:85], v246 offset:57344
    ds_read_b64_tr_b16 v[86:87], v246 offset:59392
    v_mfma_f32_32x32x16_bf16 v[48:63], v[92:95], v[172:175], v[48:63]
    buffer_load_dwordx4 v[208:211], v1, s[12:15], s29 offen offset:0 sc1
    ds_read_b64_tr_b16 v[88:89], v244 offset:61440
    ds_read_b64_tr_b16 v[90:91], v244 offset:63488
    s_waitcnt vmcnt(11) lgkmcnt(10)
    v_mfma_f32_32x32x16_bf16 v[16:31], v[112:115], v[176:179], v[16:31]
    ds_read_b64_tr_b16 v[92:93], v246 offset:61440
    ds_read_b64_tr_b16 v[94:95], v246 offset:63488
    v_mfma_f32_32x32x16_bf16 v[32:47], v[116:119], v[176:179], v[32:47]
    buffer_load_dwordx4 v[212:215], v1, s[12:15], s29 offen offset:1024 sc1
    ds_read_b64_tr_b16 v[112:113], v245 offset:0
    ds_read_b64_tr_b16 v[114:115], v245 offset:2048
    s_waitcnt vmcnt(11) lgkmcnt(10)
    v_mfma_f32_32x32x16_bf16 v[16:31], v[120:123], v[180:183], v[16:31]
    ds_read_b64_tr_b16 v[116:117], v247 offset:0
    ds_read_b64_tr_b16 v[118:119], v247 offset:2048
    v_mfma_f32_32x32x16_bf16 v[32:47], v[124:127], v[180:183], v[32:47]
    buffer_load_dwordx4 v[216:219], v1, s[12:15], s29 offen offset:2048 sc1
    ds_read_b64_tr_b16 v[120:121], v245 offset:4096
    ds_read_b64_tr_b16 v[122:123], v245 offset:6144
    s_waitcnt vmcnt(10) lgkmcnt(10)
    v_mfma_f32_32x32x16_bf16 v[16:31], v[80:83], v[184:187], v[16:31]
    ds_read_b64_tr_b16 v[124:125], v247 offset:4096
    ds_read_b64_tr_b16 v[126:127], v247 offset:6144
    v_mfma_f32_32x32x16_bf16 v[32:47], v[84:87], v[184:187], v[32:47]
    buffer_load_dwordx4 v[220:223], v1, s[12:15], s29 offen offset:3072 sc1
    s_add_u32 s29, s29, 4096
    ds_read_b64_tr_b16 v[80:81], v245 offset:8192
    ds_read_b64_tr_b16 v[82:83], v245 offset:10240
    s_waitcnt vmcnt(10) lgkmcnt(10)
    v_mfma_f32_32x32x16_bf16 v[16:31], v[88:91], v[188:191], v[16:31]
    ds_read_b64_tr_b16 v[84:85], v247 offset:8192
    ds_read_b64_tr_b16 v[86:87], v247 offset:10240
    v_mfma_f32_32x32x16_bf16 v[32:47], v[92:95], v[188:191], v[32:47]
    buffer_load_dwordx4 v[224:227], v1, s[12:15], s29 offen offset:0 sc1
    ds_read_b64_tr_b16 v[88:89], v245 offset:12288
    ds_read_b64_tr_b16 v[90:91], v245 offset:14336
    s_waitcnt vmcnt(9) lgkmcnt(10)
    v_mfma_f32_32x32x16_bf16 v[16:31], v[112:115], v[192:195], v[16:31]
    s_barrier
    ds_read_b64_tr_b16 v[92:93], v247 offset:12288
    ds_read_b64_tr_b16 v[94:95], v247 offset:14336
    v_mfma_f32_32x32x16_bf16 v[32:47], v[116:119], v[192:195], v[32:47]
    buffer_load_dwordx4 v[228:231], v1, s[12:15], s29 offen offset:1024 sc1
    ds_read_b64_tr_b16 v[112:113], v245 offset:16384
    ds_read_b64_tr_b16 v[114:115], v245 offset:18432
    s_waitcnt vmcnt(9) lgkmcnt(10)
    v_mfma_f32_32x32x16_bf16 v[16:31], v[120:123], v[196:199], v[16:31]
    ds_read_b64_tr_b16 v[116:117], v247 offset:16384
    ds_read_b64_tr_b16 v[118:119], v247 offset:18432
    v_mfma_f32_32x32x16_bf16 v[32:47], v[124:127], v[196:199], v[32:47]
    buffer_load_dwordx4 v[232:235], v1, s[12:15], s29 offen offset:2048 sc1
    ds_read_b64_tr_b16 v[120:121], v245 offset:20480
    ds_read_b64_tr_b16 v[122:123], v245 offset:22528
    s_waitcnt vmcnt(8) lgkmcnt(10)
    v_mfma_f32_32x32x16_bf16 v[16:31], v[80:83], v[200:203], v[16:31]
    ds_read_b64_tr_b16 v[124:125], v247 offset:20480
    ds_read_b64_tr_b16 v[126:127], v247 offset:22528
    v_mfma_f32_32x32x16_bf16 v[32:47], v[84:87], v[200:203], v[32:47]
    buffer_load_dwordx4 v[236:239], v1, s[12:15], s29 offen offset:3072 sc1
    s_add_u32 s29, s29, 4096
    ds_read_b64_tr_b16 v[80:81], v245 offset:24576
    ds_read_b64_tr_b16 v[82:83], v245 offset:26624
    s_waitcnt vmcnt(8) lgkmcnt(10)
    v_mfma_f32_32x32x16_bf16 v[16:31], v[88:91], v[204:207], v[16:31]
    ds_read_b64_tr_b16 v[84:85], v247 offset:24576
    ds_read_b64_tr_b16 v[86:87], v247 offset:26624
    v_mfma_f32_32x32x16_bf16 v[32:47], v[92:95], v[204:207], v[32:47]
    buffer_load_dwordx4 v[252:255], v14, s[16:19], s58 offen
    ds_read_b64_tr_b16 v[88:89], v245 offset:28672
    ds_read_b64_tr_b16 v[90:91], v245 offset:30720
    v_add_f32 v96, v96, v98
    v_add_f32 v97, v97, v99
    s_waitcnt vmcnt(8) lgkmcnt(10)
    v_mfma_f32_32x32x16_bf16 v[16:31], v[112:115], v[208:211], v[16:31]
    ds_read_b64_tr_b16 v[92:93], v247 offset:28672
    ds_read_b64_tr_b16 v[94:95], v247 offset:30720
    v_add_f32 v96, v96, v100
    v_add_f32 v97, v97, v101
    v_add_f32 v96, v96, v102
    v_mfma_f32_32x32x16_bf16 v[32:47], v[116:119], v[208:211], v[32:47]
    ds_read_b64_tr_b16 v[112:113], v245 offset:32768
    ds_read_b64_tr_b16 v[114:115], v245 offset:34816
    v_add_f32 v97, v97, v103
    v_add_f32 v96, v96, v104
    v_add_f32 v97, v97, v105
    s_waitcnt vmcnt(7) lgkmcnt(10)
    v_mfma_f32_32x32x16_bf16 v[16:31], v[120:123], v[212:215], v[16:31]
    ds_read_b64_tr_b16 v[116:117], v247 offset:32768
    ds_read_b64_tr_b16 v[118:119], v247 offset:34816
    v_add_f32 v96, v96, v106
    v_add_f32 v97, v97, v107
    v_add_f32 v96, v96, v108
    v_mfma_f32_32x32x16_bf16 v[32:47], v[124:127], v[212:215], v[32:47]
    ds_read_b64_tr_b16 v[120:121], v245 offset:36864
    ds_read_b64_tr_b16 v[122:123], v245 offset:38912
    v_add_f32 v97, v97, v109
    v_add_f32 v8, v96, v97
    v_mov_b32 v242, 0
    s_waitcnt vmcnt(6) lgkmcnt(10)
    v_mfma_f32_32x32x16_bf16 v[16:31], v[80:83], v[216:219], v[16:31]
    ds_read_b64_tr_b16 v[124:125], v247 offset:36864
    ds_read_b64_tr_b16 v[126:127], v247 offset:38912
    v_mov_b32 v9, v8
    v_mov_b32 v243, 0
    v_and_b32 v12, 31, v0
    v_mfma_f32_32x32x16_bf16 v[32:47], v[84:87], v[216:219], v[32:47]
    ds_read_b64_tr_b16 v[80:81], v245 offset:40960
    ds_read_b64_tr_b16 v[82:83], v245 offset:43008
    v_permlane32_swap_b32 v8, v9
    v_mul_f32 v8, 0xbb124925, v8
    v_mul_f32 v9, 0x3b124925, v9
    s_waitcnt vmcnt(5) lgkmcnt(10)
    v_mfma_f32_32x32x16_bf16 v[16:31], v[88:91], v[220:223], v[16:31]
    ds_read_b64_tr_b16 v[84:85], v247 offset:40960
    ds_read_b64_tr_b16 v[86:87], v247 offset:43008
    v_fma_f32 v9, -v8, v8, v9
    v_max_f32 v9, 0, v9
    v_add_f32 v9, 0x3727c5ac, v9
    v_mfma_f32_32x32x16_bf16 v[32:47], v[92:95], v[220:223], v[32:47]
    ds_read_b64_tr_b16 v[88:89], v245 offset:45056
    ds_read_b64_tr_b16 v[90:91], v245 offset:47104
    v_sqrt_f32 v10, v9
    v_rcp_f32 v9, v9
    v_cvt_pk_bf16_f32 v240, v8, v8
    s_waitcnt vmcnt(4) lgkmcnt(10)
    v_mfma_f32_32x32x16_bf16 v[16:31], v[112:115], v[224:227], v[16:31]
    ds_read_b64_tr_b16 v[92:93], v247 offset:45056
    ds_read_b64_tr_b16 v[94:95], v247 offset:47104
    v_and_b32 v11, 0xffff0000, v240
    v_sub_f32 v8, v8, v11
    v_cvt_pk_bf16_f32 v11, v10, v10
    v_mfma_f32_32x32x16_bf16 v[32:47], v[116:119], v[224:227], v[32:47]
    ds_read_b128 v[112:115], v7 offset:24576
    v_and_b32 v11, 0xffff0000, v11
    v_sub_f32 v11, v10, v11
    v_cndmask_b32 v10, v10, v11, s[64:65]
    s_waitcnt vmcnt(3) lgkmcnt(9)
    v_mfma_f32_32x32x16_bf16 v[16:31], v[120:123], v[228:231], v[16:31]
    ds_read_b128 v[116:119], v7 offset:25600
    v_cvt_pk_bf16_f32 v241, v8, v10
    s_lshl_b32 s28, s3, 7
    s_add_u32 s28, s28, 159744
    v_mfma_f32_32x32x16_bf16 v[32:47], v[124:127], v[228:231], v[32:47]
    ds_read_b64_tr_b16 v[120:121], v248 offset:49152
    ds_read_b64_tr_b16 v[122:123], v248 offset:51200
    v_lshl_add_u32 v10, v12, 2, s28
    ds_write_b32 v10, v9
    s_waitcnt vmcnt(2) lgkmcnt(9)
    v_mfma_f32_32x32x16_bf16 v[16:31], v[80:83], v[232:235], v[16:31]
    ds_read_b64_tr_b16 v[124:125], v248 offset:53248
    ds_read_b64_tr_b16 v[126:127], v248 offset:55296
    v_mfma_f32_32x32x16_bf16 v[32:47], v[84:87], v[232:235], v[32:47]
    ds_read_b64_tr_b16 v[80:81], v248 offset:57344
    ds_read_b64_tr_b16 v[82:83], v248 offset:59392
    s_waitcnt vmcnt(1) lgkmcnt(9)
    v_mfma_f32_32x32x16_bf16 v[16:31], v[88:91], v[236:239], v[16:31]
    ds_read_b64_tr_b16 v[84:85], v248 offset:61440
    ds_read_b64_tr_b16 v[86:87], v248 offset:63488
    v_mfma_f32_32x32x16_bf16 v[32:47], v[92:95], v[236:239], v[32:47]
    ds_read_b64_tr_b16 v[88:89], v249 offset:0
    ds_read_b64_tr_b16 v[90:91], v249 offset:2048
    s_waitcnt lgkmcnt(11)
    v_mfma_f32_32x32x16_bf16 v[16:31], v[112:115], v[240:243], v[16:31]
    ds_read_b64_tr_b16 v[92:93], v249 offset:4096
    ds_read_b64_tr_b16 v[94:95], v249 offset:6144
    v_mfma_f32_32x32x16_bf16 v[32:47], v[116:119], v[240:243], v[32:47]
    ds_read_b64_tr_b16 v[112:113], v249 offset:8192
    ds_read_b64_tr_b16 v[114:115], v249 offset:10240
    s_waitcnt lgkmcnt(10)
    v_mfma_f32_32x32x16_bf16 v[48:63], v[120:123], v[176:179], v[48:63]
    ds_read_b64_tr_b16 v[116:117], v249 offset:12288
    ds_read_b64_tr_b16 v[118:119], v249 offset:14336
    v_mul_f32 v16, v16, |v16|
    v_mul_f32 v17, v17, |v17|
    v_mul_f32 v18, v18, |v18|
    v_mul_f32 v19, v19, |v19|
    v_mul_f32 v20, v20, |v20|
    v_mfma_f32_32x32x16_bf16 v[48:63], v[124:127], v[180:183], v[48:63]
    ds_read_b64_tr_b16 v[120:121], v249 offset:16384
    ds_read_b64_tr_b16 v[122:123], v249 offset:18432
    v_mul_f32 v21, v21, |v21|
    v_mul_f32 v22, v22, |v22|
    v_mul_f32 v23, v23, |v23|
    v_cvt_pk_bf16_f32 v96, v16, v17
    v_cvt_pk_bf16_f32 v97, v18, v19
    s_waitcnt lgkmcnt(10)
    v_mfma_f32_32x32x16_bf16 v[48:63], v[80:83], v[184:187], v[48:63]
    ds_read_b64_tr_b16 v[124:125], v249 offset:20480
    ds_read_b64_tr_b16 v[126:127], v249 offset:22528
    v_cvt_pk_bf16_f32 v98, v20, v21
    v_cvt_pk_bf16_f32 v99, v22, v23
    v_pk_max_i16 v96, v96, 0
    v_pk_max_i16 v97, v97, 0
    v_pk_max_i16 v98, v98, 0
    v_mfma_f32_32x32x16_bf16 v[48:63], v[84:87], v[188:191], v[48:63]
    ds_read_b64_tr_b16 v[80:81], v249 offset:24576
    ds_read_b64_tr_b16 v[82:83], v249 offset:26624
    v_pk_max_i16 v99, v99, 0
    buffer_store_dwordx4 v[96:99], v1, s[12:15], s59 offen offset:0
    v_mul_f32 v24, v24, |v24|
    v_mul_f32 v25, v25, |v25|
    s_waitcnt lgkmcnt(10)
    v_mfma_f32_32x32x16_bf16 v[48:63], v[88:91], v[192:195], v[48:63]
    ds_read_b64_tr_b16 v[84:85], v249 offset:28672
    ds_read_b64_tr_b16 v[86:87], v249 offset:30720
    v_mul_f32 v26, v26, |v26|
    v_mul_f32 v27, v27, |v27|
    v_mul_f32 v28, v28, |v28|
    v_mul_f32 v29, v29, |v29|
    v_mul_f32 v30, v30, |v30|
    v_mfma_f32_32x32x16_bf16 v[48:63], v[92:95], v[196:199], v[48:63]
    ds_read_b64_tr_b16 v[88:89], v249 offset:32768
    ds_read_b64_tr_b16 v[90:91], v249 offset:34816
    v_mul_f32 v31, v31, |v31|
    v_cvt_pk_bf16_f32 v100, v24, v25
    v_cvt_pk_bf16_f32 v101, v26, v27
    v_cvt_pk_bf16_f32 v102, v28, v29
    v_cvt_pk_bf16_f32 v103, v30, v31
    s_waitcnt lgkmcnt(10)
    v_mfma_f32_32x32x16_bf16 v[48:63], v[112:115], v[200:203], v[48:63]
    ds_read_b64_tr_b16 v[92:93], v249 offset:36864
    ds_read_b64_tr_b16 v[94:95], v249 offset:38912
    v_pk_max_i16 v100, v100, 0
    v_pk_max_i16 v101, v101, 0
    v_pk_max_i16 v102, v102, 0
    v_pk_max_i16 v103, v103, 0
    buffer_store_dwordx4 v[100:103], v1, s[12:15], s59 offen offset:1024
    v_mfma_f32_32x32x16_bf16 v[48:63], v[116:119], v[204:207], v[48:63]
    ds_read_b64_tr_b16 v[112:113], v249 offset:40960
    ds_read_b64_tr_b16 v[114:115], v249 offset:43008
    v_mul_f32 v32, v32, |v32|
    v_mul_f32 v33, v33, |v33|
    v_mul_f32 v34, v34, |v34|
    v_mul_f32 v35, v35, |v35|
    s_waitcnt lgkmcnt(10)
    v_mfma_f32_32x32x16_bf16 v[48:63], v[120:123], v[208:211], v[48:63]
    ds_read_b64_tr_b16 v[116:117], v249 offset:45056
    ds_read_b64_tr_b16 v[118:119], v249 offset:47104
    v_mul_f32 v36, v36, |v36|
    v_mul_f32 v37, v37, |v37|
    v_mul_f32 v38, v38, |v38|
    v_mul_f32 v39, v39, |v39|
    v_cvt_pk_bf16_f32 v104, v32, v33
    v_mfma_f32_32x32x16_bf16 v[48:63], v[124:127], v[212:215], v[48:63]
    ds_read_b128 v[120:123], v7 offset:26624
    v_cvt_pk_bf16_f32 v105, v34, v35
    v_cvt_pk_bf16_f32 v106, v36, v37
    v_cvt_pk_bf16_f32 v107, v38, v39
    v_pk_max_i16 v104, v104, 0
    v_pk_max_i16 v105, v105, 0
    s_waitcnt lgkmcnt(9)
    v_mfma_f32_32x32x16_bf16 v[48:63], v[80:83], v[216:219], v[48:63]
    ds_read_b64_tr_b16 v[124:125], v250 offset:0
    ds_read_b64_tr_b16 v[126:127], v250 offset:2048
    v_pk_max_i16 v106, v106, 0
    v_pk_max_i16 v107, v107, 0
    buffer_store_dwordx4 v[104:107], v1, s[12:15], s59 offen offset:2048
    v_mul_f32 v40, v40, |v40|
    v_mfma_f32_32x32x16_bf16 v[48:63], v[84:87], v[220:223], v[48:63]
    ds_read_b64_tr_b16 v[80:81], v250 offset:4096
    ds_read_b64_tr_b16 v[82:83], v250 offset:6144
    v_mul_f32 v41, v41, |v41|
    v_mul_f32 v42, v42, |v42|
    v_mul_f32 v43, v43, |v43|
    v_mul_f32 v44, v44, |v44|
    v_mul_f32 v45, v45, |v45|
    s_waitcnt lgkmcnt(9)
    v_mfma_f32_32x32x16_bf16 v[48:63], v[88:91], v[224:227], v[48:63]
    ds_read_b64_tr_b16 v[84:85], v250 offset:8192
    ds_read_b64_tr_b16 v[86:87], v250 offset:10240
    v_mul_f32 v46, v46, |v46|
    v_mul_f32 v47, v47, |v47|
    v_cvt_pk_bf16_f32 v108, v40, v41
    v_cvt_pk_bf16_f32 v109, v42, v43
    v_cvt_pk_bf16_f32 v110, v44, v45
    v_mfma_f32_32x32x16_bf16 v[48:63], v[92:95], v[228:231], v[48:63]
    ds_read_b64_tr_b16 v[88:89], v250 offset:12288
    ds_read_b64_tr_b16 v[90:91], v250 offset:14336
    v_cvt_pk_bf16_f32 v111, v46, v47
    v_pk_max_i16 v108, v108, 0
    v_pk_max_i16 v109, v109, 0
    v_pk_max_i16 v110, v110, 0
    v_pk_max_i16 v111, v111, 0
    s_waitcnt lgkmcnt(9)
    v_mfma_f32_32x32x16_bf16 v[48:63], v[112:115], v[232:235], v[48:63]
    ds_read_b64_tr_b16 v[92:93], v250 offset:16384
    ds_read_b64_tr_b16 v[94:95], v250 offset:18432
    buffer_store_dwordx4 v[108:111], v1, s[12:15], s59 offen offset:3072
    v_mfma_f32_32x32x16_bf16 v[48:63], v[116:119], v[236:239], v[48:63]
    ds_read_b64_tr_b16 v[112:113], v250 offset:20480
    ds_read_b64_tr_b16 v[114:115], v250 offset:22528
    s_waitcnt lgkmcnt(10)
    v_mfma_f32_32x32x16_bf16 v[48:63], v[120:123], v[240:243], v[48:63]
    ds_read_b64_tr_b16 v[116:117], v250 offset:24576
    ds_read_b64_tr_b16 v[118:119], v250 offset:26624
    v_mfma_f32_32x32x16_bf16 v[64:79], v[124:127], v[128:131], 0
    ds_read_b64_tr_b16 v[120:121], v250 offset:28672
    ds_read_b64_tr_b16 v[122:123], v250 offset:30720
    s_waitcnt lgkmcnt(10)
    v_mfma_f32_32x32x16_bf16 v[64:79], v[80:83], v[132:135], v[64:79]
    ds_read_b64_tr_b16 v[124:125], v250 offset:32768
    ds_read_b64_tr_b16 v[126:127], v250 offset:34816
    v_mfma_f32_32x32x16_bf16 v[64:79], v[84:87], v[136:139], v[64:79]
    ds_read_b64_tr_b16 v[80:81], v250 offset:36864
    ds_read_b64_tr_b16 v[82:83], v250 offset:38912
    v_mul_f32 v48, v48, |v48|
    v_mul_f32 v49, v49, |v49|
    v_mul_f32 v50, v50, |v50|
    v_mul_f32 v51, v51, |v51|
    v_mul_f32 v52, v52, |v52|
    s_waitcnt lgkmcnt(10)
    v_mfma_f32_32x32x16_bf16 v[64:79], v[88:91], v[140:143], v[64:79]
    ds_read_b64_tr_b16 v[84:85], v250 offset:40960
    ds_read_b64_tr_b16 v[86:87], v250 offset:43008
    v_mul_f32 v53, v53, |v53|
    v_mul_f32 v54, v54, |v54|
    v_mul_f32 v55, v55, |v55|
    v_cvt_pk_bf16_f32 v96, v48, v49
    v_cvt_pk_bf16_f32 v97, v50, v51
    v_mfma_f32_32x32x16_bf16 v[64:79], v[92:95], v[144:147], v[64:79]
    ds_read_b64_tr_b16 v[88:89], v250 offset:45056
    ds_read_b64_tr_b16 v[90:91], v250 offset:47104
    v_cvt_pk_bf16_f32 v98, v52, v53
    v_cvt_pk_bf16_f32 v99, v54, v55
    v_pk_max_i16 v96, v96, 0
    v_pk_max_i16 v97, v97, 0
    v_pk_max_i16 v98, v98, 0
    s_waitcnt lgkmcnt(10)
    v_mfma_f32_32x32x16_bf16 v[64:79], v[112:115], v[148:151], v[64:79]
    ds_read_b64_tr_b16 v[92:93], v250 offset:49152
    ds_read_b64_tr_b16 v[94:95], v250 offset:51200
    v_pk_max_i16 v99, v99, 0
    buffer_store_dwordx4 v[96:99], v1, s[12:15], s31 offen offset:0
    v_mul_f32 v56, v56, |v56|
    v_mul_f32 v57, v57, |v57|
    v_mov_b32 v5, s25
    s_cmp_lg_u32 s26, 0
    s_waitcnt vmcnt(1)
    buffer_store_dword v5, v2, s[12:15], s32 offen
    s_cbranch_scc1 Lpubg_10
Lpubd_11:
    v_mfma_f32_32x32x16_bf16 v[64:79], v[116:119], v[152:155], v[64:79]
    ds_read_b64_tr_b16 v[112:113], v250 offset:53248
    ds_read_b64_tr_b16 v[114:115], v250 offset:55296
    v_mul_f32 v58, v58, |v58|
    v_mul_f32 v59, v59, |v59|
    v_mul_f32 v60, v60, |v60|
    v_mul_f32 v61, v61, |v61|
    v_mul_f32 v62, v62, |v62|
    s_waitcnt lgkmcnt(10)
    v_mfma_f32_32x32x16_bf16 v[64:79], v[120:123], v[156:159], v[64:79]
    ds_read_b64_tr_b16 v[116:117], v250 offset:57344
    ds_read_b64_tr_b16 v[118:119], v250 offset:59392
    v_mul_f32 v63, v63, |v63|
    v_cvt_pk_bf16_f32 v100, v56, v57
    v_cvt_pk_bf16_f32 v101, v58, v59
    v_cvt_pk_bf16_f32 v102, v60, v61
    v_cvt_pk_bf16_f32 v103, v62, v63
    v_mfma_f32_32x32x16_bf16 v[64:79], v[124:127], v[160:163], v[64:79]
    ds_read_b64_tr_b16 v[120:121], v250 offset:61440
    ds_read_b64_tr_b16 v[122:123], v250 offset:63488
    v_pk_max_i16 v100, v100, 0
    v_pk_max_i16 v101, v101, 0
    v_pk_max_i16 v102, v102, 0
    v_pk_max_i16 v103, v103, 0
    buffer_store_dwordx4 v[100:103], v1, s[12:15], s31 offen offset:1024
    s_waitcnt lgkmcnt(10)
    v_mfma_f32_32x32x16_bf16 v[64:79], v[80:83], v[164:167], v[64:79]
    ds_read_b64_tr_b16 v[124:125], v251 offset:0
    ds_read_b64_tr_b16 v[126:127], v251 offset:2048
    v_mfma_f32_32x32x16_bf16 v[64:79], v[84:87], v[168:171], v[64:79]
    ds_read_b64_tr_b16 v[80:81], v251 offset:4096
    ds_read_b64_tr_b16 v[82:83], v251 offset:6144
    s_waitcnt lgkmcnt(10)
    v_mfma_f32_32x32x16_bf16 v[64:79], v[88:91], v[172:175], v[64:79]
    ds_read_b64_tr_b16 v[84:85], v251 offset:8192
    ds_read_b64_tr_b16 v[86:87], v251 offset:10240
    v_mfma_f32_32x32x16_bf16 v[64:79], v[92:95], v[176:179], v[64:79]
    ds_read_b64_tr_b16 v[88:89], v251 offset:12288
    ds_read_b64_tr_b16 v[90:91], v251 offset:14336
    s_barrier
    s_waitcnt lgkmcnt(10)
    v_mfma_f32_32x32x16_bf16 v[64:79], v[112:115], v[180:183], v[64:79]
    ds_read_b64_tr_b16 v[92:93], v251 offset:16384
    ds_read_b64_tr_b16 v[94:95], v251 offset:18432
    v_mfma_f32_32x32x16_bf16 v[64:79], v[116:119], v[184:187], v[64:79]
    ds_read_b64_tr_b16 v[112:113], v251 offset:20480
    ds_read_b64_tr_b16 v[114:115], v251 offset:22528
    s_waitcnt lgkmcnt(10)
    v_mfma_f32_32x32x16_bf16 v[64:79], v[120:123], v[188:191], v[64:79]
    ds_read_b64_tr_b16 v[116:117], v251 offset:24576
    ds_read_b64_tr_b16 v[118:119], v251 offset:26624
    v_mfma_f32_32x32x16_bf16 v[64:79], v[124:127], v[192:195], v[64:79]
    ds_read_b64_tr_b16 v[120:121], v251 offset:28672
    ds_read_b64_tr_b16 v[122:123], v251 offset:30720
    s_waitcnt lgkmcnt(10)
    v_mfma_f32_32x32x16_bf16 v[64:79], v[80:83], v[196:199], v[64:79]
    ds_read_b64_tr_b16 v[124:125], v251 offset:32768
    ds_read_b64_tr_b16 v[126:127], v251 offset:34816
    v_mfma_f32_32x32x16_bf16 v[64:79], v[84:87], v[200:203], v[64:79]
    ds_read_b64_tr_b16 v[80:81], v251 offset:36864
    ds_read_b64_tr_b16 v[82:83], v251 offset:38912
    s_waitcnt lgkmcnt(10)
    v_mfma_f32_32x32x16_bf16 v[64:79], v[88:91], v[204:207], v[64:79]
    ds_read_b64_tr_b16 v[84:85], v251 offset:40960
    ds_read_b64_tr_b16 v[86:87], v251 offset:43008
    v_mfma_f32_32x32x16_bf16 v[64:79], v[92:95], v[208:211], v[64:79]
    ds_read_b64_tr_b16 v[88:89], v251 offset:45056
    ds_read_b64_tr_b16 v[90:91], v251 offset:47104
    s_waitcnt lgkmcnt(10)
    v_mfma_f32_32x32x16_bf16 v[64:79], v[112:115], v[212:215], v[64:79]
    ds_read_b128 v[92:95], v7 offset:27648
    v_mfma_f32_32x32x16_bf16 v[64:79], v[116:119], v[216:219], v[64:79]
    s_waitcnt lgkmcnt(7)
    v_mfma_f32_32x32x16_bf16 v[64:79], v[120:123], v[220:223], v[64:79]
    v_mfma_f32_32x32x16_bf16 v[64:79], v[124:127], v[224:227], v[64:79]
    s_waitcnt lgkmcnt(3)
    v_mfma_f32_32x32x16_bf16 v[64:79], v[80:83], v[228:231], v[64:79]
    v_mfma_f32_32x32x16_bf16 v[64:79], v[84:87], v[232:235], v[64:79]
    s_waitcnt lgkmcnt(0)
    v_mfma_f32_32x32x16_bf16 v[64:79], v[88:91], v[236:239], v[64:79]
    v_mfma_f32_32x32x16_bf16 v[64:79], v[92:95], v[240:243], v[64:79]
LA_tail:
    s_nop 11
    v_mul_f32 v64, v64, |v64|
    v_mul_f32 v65, v65, |v65|
    v_mul_f32 v66, v66, |v66|
    v_mul_f32 v67, v67, |v67|
    v_mul_f32 v68, v68, |v68|
    v_mul_f32 v69, v69, |v69|
    v_mul_f32 v70, v70, |v70|
    v_mul_f32 v71, v71, |v71|
    v_cvt_pk_bf16_f32 v104, v64, v65
    v_cvt_pk_bf16_f32 v105, v66, v67
    v_cvt_pk_bf16_f32 v106, v68, v69
    v_cvt_pk_bf16_f32 v107, v70, v71
    v_pk_max_i16 v104, v104, 0
    v_pk_max_i16 v105, v105, 0
    v_pk_max_i16 v106, v106, 0
    v_pk_max_i16 v107, v107, 0
    v_mul_f32 v72, v72, |v72|
    v_mul_f32 v73, v73, |v73|
    v_mul_f32 v74, v74, |v74|
    v_mul_f32 v75, v75, |v75|
    v_mul_f32 v76, v76, |v76|
    v_mul_f32 v77, v77, |v77|
    v_mul_f32 v78, v78, |v78|
    v_mul_f32 v79, v79, |v79|
    v_cvt_pk_bf16_f32 v108, v72, v73
    v_cvt_pk_bf16_f32 v109, v74, v75
    v_cvt_pk_bf16_f32 v110, v76, v77
    v_cvt_pk_bf16_f32 v111, v78, v79
    v_pk_max_i16 v108, v108, 0
    v_pk_max_i16 v109, v109, 0
    v_pk_max_i16 v110, v110, 0
    v_pk_max_i16 v111, v111, 0
    s_add_u32 s32, s32, 64
    s_lshl_b32 s28, s76, 7
    s_add_u32 s28, s28, 24640
    v_and_b32 v8, 31, v0
    v_min_u32 v8, 13, v8
    v_and_b32 v9, 32, v0
    v_add_lshl_u32 v8, v8, v9, 2
    v_mov_b32 v26, v1
    v_lshrrev_b32 v24, 5, v14
    v_lshlrev_b32 v24, 10, v24
    v_lshl_add_u32 v24, v13, 4, v24
    v_bfe_u32 v11, v14, 4, 1
    v_lshl_add_u32 v24, v11, 3, v24
    v_add_u32 v24, 114688, v24
    v_mul_u32_u24 v27, 272, v13
    v_lshl_add_u32 v27, v14, 1, v27
    v_add_u32 v27, 114688, v27
    s_and_b32 s33, s76, 3
    s_lshl_b32 s33, s33, 7
    s_add_u32 s33, s33, 159744
    v_lshl_add_u32 v4, v13, 2, s33
    v_mul_u32_u24 v11, 896, v13
    v_add_u32 v11, v11, v14
    ds_read_b32 v12, v4
    ds_read_b32 v13, v4 offset:128
    s_mul_i32 s33, s76, 28672
    s_add_u32 s58, s58, s33
    s_xor_b32 s33, s76, s74
    s_cmp_gt_u32 s33, 1
    s_cbranch_scc1 LA_rwd
    s_lshl_b32 s33, s33, 12
    s_add_u32 s33, s33, 114688
    v_add_u32 v25, s33, v26
    s_cmp_ge_u32 s77, 3
    s_cbranch_scc1 LA_rw3
    s_cmp_ge_u32 s77, 1
    s_cbranch_scc1 LA_rw1
    ds_write_b128 v25, v[128:131] offset:0
    ds_write_b128 v25, v[132:135] offset:1024
    ds_write_b128 v25, v[136:139] offset:2048
    ds_write_b128 v25, v[140:143] offset:3072
    s_branch LA_rwd
LA_rw1:
    s_cmp_ge_u32 s77, 2
    s_cbranch_scc1 LA_rw2
    ds_write_b128 v25, v[144:147] offset:0
    ds_write_b128 v25, v[148:151] offset:1024
    ds_write_b128 v25, v[152:155] offset:2048
    ds_write_b128 v25, v[156:159] offset:3072
    s_branch LA_rwd
LA_rw2:
    ds_write_b128 v25, v[160:163] offset:0
    ds_write_b128 v25, v[164:167] offset:1024
    ds_write_b128 v25, v[168:171] offset:2048
    ds_write_b128 v25, v[172:175] offset:3072
    s_branch LA_rwd
LA_rw3:
    s_cmp_ge_u32 s77, 5
    s_cbranch_scc1 LA_rw5
    s_cmp_ge_u32 s77, 4
    s_cbranch_scc1 LA_rw4
    ds_write_b128 v25, v[176:179] offset:0
    ds_write_b128 v25, v[180:183] offset:1024
    ds_write_b128 v25, v[184:187] offset:2048
    ds_write_b128 v25, v[188:191] offset:3072
    s_branch LA_rwd
LA_rw4:
    ds_write_b128 v25, v[192:195] offset:0
    ds_write_b128 v25, v[196:199] offset:1024
    ds_write_b128 v25, v[200:203] offset:2048
    ds_write_b128 v25, v[204:207] offset:3072
    s_branch LA_rwd
LA_rw5:
    s_cmp_ge_u32 s77, 6
    s_cbranch_scc1 LA_rw6
    ds_write_b128 v25, v[208:211] offset:0
    ds_write_b128 v25, v[212:215] offset:1024
    ds_write_b128 v25, v[216:219] offset:2048
    ds_write_b128 v25, v[220:223] offset:3072
    s_branch LA_rwd
LA_rw6:
    ds_write_b128 v25, v[224:227] offset:0
    ds_write_b128 v25, v[228:231] offset:1024
    ds_write_b128 v25, v[232:235] offset:2048
    ds_write_b128 v25, v[236:239] offset:3072
LA_rwd:
    s_waitcnt lgkmcnt(0)
    s_barrier
    buffer_store_dwordx4 v[104:107], v1, s[12:15], s60 offen offset:2048
    buffer_store_dwordx4 v[108:111], v1, s[12:15], s60 offen offset:3072
    s_barrier
    v_mov_b32 v5, s25
    s_cmp_lg_u32 s26, 0
    s_waitcnt vmcnt(0)
    buffer_store_dword v5, v2, s[12:15], s32 offen
    s_cbranch_scc1 Lpubg_12
Lpubd_13:
    s_barrier
    ds_read_b64 v[16:17], v24 offset:0
    ds_read_b64 v[18:19], v24 offset:512
    ds_read_b64 v[20:21], v24 offset:4096
    ds_read_b64 v[22:23], v24 offset:4608
    s_barrier
    buffer_load_dword v9, v8, s[12:15], s28 offen sc1
    s_barrier
    s_cmp_lg_u32 s26, 0
    s_waitcnt vmcnt(0)
    s_cbranch_scc1 Lpollg_15
Lpoll_14:
    v_cmp_ne_u32 vcc, s25, v9
    s_cbranch_vccnz Lpollr_17
Lpolld_16:
    s_barrier
    s_waitcnt lgkmcnt(0)
    v_lshlrev_b32 v6, 16, v252
    v_and_b32 v7, 0xffff0000, v252
    v_lshlrev_b32 v32, 16, v16
    v_and_b32 v33, 0xffff0000, v16
    v_add_f32 v32, v32, v6
    v_add_f32 v33, v33, v7
    s_barrier
    v_lshlrev_b32 v6, 16, v253
    v_and_b32 v7, 0xffff0000, v253
    v_lshlrev_b32 v34, 16, v17
    v_and_b32 v35, 0xffff0000, v17
    v_add_f32 v34, v34, v6
    v_add_f32 v35, v35, v7
    s_barrier
    v_lshlrev_b32 v6, 16, v254
    v_and_b32 v7, 0xffff0000, v254
    v_lshlrev_b32 v36, 16, v18
    v_and_b32 v37, 0xffff0000, v18
    v_add_f32 v36, v36, v6
    v_add_f32 v37, v37, v7
    s_barrier
    v_lshlrev_b32 v6, 16, v255
    v_and_b32 v7, 0xffff0000, v255
    v_lshlrev_b32 v38, 16, v19
    v_and_b32 v39, 0xffff0000, v19
    v_add_f32 v38, v38, v6
    v_add_f32 v39, v39, v7
    s_barrier
    v_lshlrev_b32 v6, 16, v252
    v_and_b32 v7, 0xffff0000, v252
    v_lshlrev_b32 v40, 16, v20
    v_and_b32 v41, 0xffff0000, v20
    v_add_f32 v40, v40, v6
    v_add_f32 v41, v41, v7
    s_barrier
    v_lshlrev_b32 v6, 16, v253
    v_and_b32 v7, 0xffff0000, v253
    v_lshlrev_b32 v42, 16, v21
    v_and_b32 v43, 0xffff0000, v21
    v_add_f32 v42, v42, v6
    v_add_f32 v43, v43, v7
    s_barrier
    v_lshlrev_b32 v6, 16, v254
    v_and_b32 v7, 0xffff0000, v254
    v_lshlrev_b32 v44, 16, v22
    v_and_b32 v45, 0xffff0000, v22
    v_add_f32 v44, v44, v6
    v_add_f32 v45, v45, v7
    s_barrier
    v_lshlrev_b32 v6, 16, v255
    v_and_b32 v7, 0xffff0000, v255
    v_lshlrev_b32 v46, 16, v23
    v_and_b32 v47, 0xffff0000, v23
    v_add_f32 v46, v46, v6
    v_add_f32 v47, v47, v7
    s_or_b32 s33, s5, s3
    s_cbranch_scc1 LA_nwb
    buffer_wbl2 sc1
LA_nwb:
    s_barrier
    s_or_b32 s33, s2, s3
    s_cselect_b32 s33, 1073741824, 0
    v_mov_b32 v6, s24
    buffer_store_dword v6, v2, s[12:15], s33 offen sc1
    ds_read_b128 v[48:51], v27 offset:0
    ds_read_b128 v[52:55], v27 offset:16
    ds_read_b128 v[56:59], v27 offset:8704
    ds_read_b128 v[60:63], v27 offset:8720
    s_waitcnt lgkmcnt(0)
    v_add_f32 v48, v48, v56
    v_add_f32 v49, v49, v57
    v_add_f32 v50, v50, v58
    v_add_f32 v51, v51, v59
    v_add_f32 v52, v52, v60
    v_add_f32 v53, v53, v61
    v_add_f32 v54, v54, v62
    v_add_f32 v55, v55, v63
    v_fma_f32 v48, v48, v12, v32
    v_fma_f32 v49, v49, v12, v33
    v_fma_f32 v50, v50, v12, v34
    v_fma_f32 v51, v51, v12, v35
    v_fma_f32 v52, v52, v12, v36
    v_fma_f32 v53, v53, v12, v37
    v_fma_f32 v54, v54, v12, v38
    v_fma_f32 v55, v55, v12, v39
    v_cvt_pk_bf16_f32 v64, v48, v49
    v_cvt_pk_bf16_f32 v65, v50, v51
    v_cvt_pk_bf16_f32 v66, v52, v53
    v_cvt_pk_bf16_f32 v67, v54, v55
    buffer_store_dwordx4 v[64:67], v11, s[20:23], s58 offen sc1
    s_add_u32 s58, s58, 28672
    s_barrier
    ds_read_b128 v[48:51], v27 offset:17408
    ds_read_b128 v[52:55], v27 offset:17424
    ds_read_b128 v[56:59], v27 offset:26112
    ds_read_b128 v[60:63], v27 offset:26128
    s_waitcnt lgkmcnt(0)
    v_add_f32 v48, v48, v56
    v_add_f32 v49, v49, v57
    v_add_f32 v50, v50, v58
    v_add_f32 v51, v51, v59
    v_add_f32 v52, v52, v60
    v_add_f32 v53, v53, v61
    v_add_f32 v54, v54, v62
    v_add_f32 v55, v55, v63
    v_fma_f32 v48, v48, v13, v40
    v_fma_f32 v49, v49, v13, v41
    v_fma_f32 v50, v50, v13, v42
    v_fma_f32 v51, v51, v13, v43
    v_fma_f32 v52, v52, v13, v44
    v_fma_f32 v53, v53, v13, v45
    v_fma_f32 v54, v54, v13, v46
    v_fma_f32 v55, v55, v13, v47
    v_cvt_pk_bf16_f32 v68, v48, v49
    v_cvt_pk_bf16_f32 v69, v50, v51
    v_cvt_pk_bf16_f32 v70, v52, v53
    v_cvt_pk_bf16_f32 v71, v54, v55
    buffer_store_dwordx4 v[68:71], v11, s[20:23], s58 offen sc1
    s_endpgm
LA_idle:
    s_endpgm
    .fill 608, 4, 0xbf800000
LB_att:
    s_barrier
    s_lshl2_add_u32 s30, s7, s68
    s_and_b32 s31, s30, 7
    s_lshl_b32 s31, s31, 4
    s_add_u32 s31, s31, s6
    s_lshl_b32 s31, s31, 11
    s_lshr_b32 s32, s30, 3
    s_lshl_b32 s32, s32, 20
    s_add_u32 s31, s31, s32
    s_add_u32 s31, s31, 7077888
    s_mov_b32 s32, 0x53800000
    s_mov_b32 s33, 0x2b800000
    s_cmp_lg_u32 s26, 0
    s_cbranch_scc1 Lpollg_20
Lpoll_19:
    buffer_load_dword v10, v3, s[12:15], s28 offen sc1
    s_sub_u32 s27, s27, 1
    s_waitcnt vmcnt(0)
    v_cmp_ne_u32 vcc, s25, v10
    s_cbranch_scc1 Lpollr_22
    s_cbranch_vccnz Lpoll_19
Lpolld_21:
    s_waitcnt lgkmcnt(0)
    s_add_u32 s28, s71, 147456
    v_add_u32 v3, s28, v1
    s_add_u32 m0, s71, 65536
    s_add_u32 s54, s54, 16384
    s_and_b32 s54, s54, 245760
    buffer_load_dwordx4 v96, s[12:15], s54 offen offset:0 sc1 lds
    buffer_load_dwordx4 v96, s[12:15], s54 offen offset:1024 sc1 lds
    buffer_load_dwordx4 v96, s[12:15], s54 offen offset:2048 sc1 lds
    buffer_load_dwordx4 v96, s[12:15], s54 offen offset:3072 sc1 lds
    s_add_u32 m0, s71, 81920
    s_add_u32 s54, s54, 16384
    s_and_b32 s54, s54, 245760
    buffer_load_dwordx4 v96, s[12:15], s54 offen offset:0 sc1 lds
    buffer_load_dwordx4 v96, s[12:15], s54 offen offset:1024 sc1 lds
    buffer_load_dwordx4 v96, s[12:15], s54 offen offset:2048 sc1 lds
    buffer_load_dwordx4 v96, s[12:15], s54 offen offset:3072 sc1 lds
    s_barrier
    ds_read_b128 v[80:83], v9
    ds_read_b128 v[84:87], v9 offset:1024
    ds_read_b128 v[64:67], v4 offset:0
    ds_read_b128 v[68:71], v4 offset:1024
    s_setprio 2
    s_waitcnt lgkmcnt(1)
    v_mfma_f32_32x32x16_bf16 v[32:47], v[64:67], v[80:83], 0
    ds_read_b128 v[64:67], v4 offset:4096
    s_add_u32 m0, s71, 98304
    s_add_u32 s54, s54, 16384
    s_and_b32 s54, s54, 245760
    buffer_load_dwordx4 v96, s[12:15], s54 offen offset:2048 sc1 lds
    s_waitcnt lgkmcnt(1)
    v_mfma_f32_32x32x16_bf16 v[32:47], v[68:71], v[84:87], v[32:47]
    ds_read_b128 v[68:71], v4 offset:5120
    buffer_load_dwordx4 v96, s[12:15], s54 offen offset:3072 sc1 lds
    ds_read_b128 v[72:75], v4 offset:2048
    ds_read_b128 v[76:79], v4 offset:3072
    s_setprio 0
    s_nop 6
    v_exp_f32 v32, v32
    v_exp_f32 v33, v33
    v_exp_f32 v34, v34
    v_exp_f32 v35, v35
    v_exp_f32 v36, v36
    v_exp_f32 v37, v37
    v_exp_f32 v38, v38
    v_exp_f32 v39, v39
    s_setprio 1
    v_exp_f32 v40, v40
    v_exp_f32 v41, v41
    v_exp_f32 v42, v42
    v_exp_f32 v43, v43
    v_exp_f32 v44, v44
    v_exp_f32 v45, v45
    v_exp_f32 v46, v46
    v_exp_f32 v47, v47
    s_setprio 2
    s_waitcnt lgkmcnt(3)
    v_mfma_f32_32x32x16_bf16 v[48:63], v[64:67], v[80:83], 0
    s_mov_b32 m0, s91
    s_add_u32 s28, s87, 0
    buffer_load_dwordx4 v90, s[36:39], s28 offen offset:0 lds
    s_waitcnt lgkmcnt(2)
    v_mfma_f32_32x32x16_bf16 v[48:63], v[68:71], v[84:87], v[48:63]
    s_mov_b32 m0, s91
    s_add_u32 s28, s87, 6144
    buffer_load_dwordx4 v90, s[36:39], s28 offen offset:1024 lds
    s_waitcnt lgkmcnt(1)
    v_smfmac_f32_32x32x32_bf16 v[16:31], v[72:75], v[32:39], v7
    ds_read_b128 v[72:75], v4 offset:6144
    s_waitcnt lgkmcnt(1)
    v_smfmac_f32_32x32x32_bf16 v[16:31], v[76:79], v[40:47], v7
    ds_read_b128 v[76:79], v4 offset:7168
    s_waitcnt vmcnt(4)
    s_barrier
    ds_read_b128 v[64:67], v5 offset:0
    ds_read_b128 v[68:71], v5 offset:1024
    s_setprio 0
    v_exp_f32 v48, v48
    v_exp_f32 v49, v49
    v_exp_f32 v50, v50
    v_exp_f32 v51, v51
    v_exp_f32 v52, v52
    v_exp_f32 v53, v53
    v_exp_f32 v54, v54
    v_exp_f32 v55, v55
    s_setprio 1
    v_exp_f32 v56, v56
    v_exp_f32 v57, v57
    v_exp_f32 v58, v58
    v_exp_f32 v59, v59
    v_exp_f32 v60, v60
    v_exp_f32 v61, v61
    v_exp_f32 v62, v62
    v_exp_f32 v63, v63
    s_setprio 2
    s_waitcnt lgkmcnt(1)
    v_mfma_f32_32x32x16_bf16 v[32:47], v[64:67], v[80:83], 0
    ds_read_b128 v[64:67], v5 offset:4096
    buffer_load_dword v110, v93, s[20:23], s100 offen
    s_waitcnt lgkmcnt(1)
    v_mfma_f32_32x32x16_bf16 v[32:47], v[68:71], v[84:87], v[32:47]
    ds_read_b128 v[68:71], v5 offset:5120
    buffer_load_dword v110, v2, s[12:15], s101 offen sc1
    v_smfmac_f32_32x32x32_bf16 v[16:31], v[72:75], v[48:55], v7
    ds_read_b128 v[72:75], v5 offset:2048
    v_smfmac_f32_32x32x32_bf16 v[16:31], v[76:79], v[56:63], v7
    ds_read_b128 v[76:79], v5 offset:3072
    s_setprio 0
    v_exp_f32 v32, v32
    v_exp_f32 v33, v33
    v_exp_f32 v34, v34
    v_exp_f32 v35, v35
    v_exp_f32 v36, v36
    v_exp_f32 v37, v37
    v_exp_f32 v38, v38
    v_exp_f32 v39, v39
    s_setprio 1
    v_exp_f32 v40, v40
    v_exp_f32 v41, v41
    v_exp_f32 v42, v42
    v_exp_f32 v43, v43
    v_exp_f32 v44, v44
    v_exp_f32 v45, v45
    v_exp_f32 v46, v46
    v_exp_f32 v47, v47
    s_setprio 2
    s_waitcnt lgkmcnt(3)
    v_mfma_f32_32x32x16_bf16 v[48:63], v[64:67], v[80:83], 0
    ds_read_b128 v[64:67], v5 offset:16384
    s_add_u32 m0, s71, 131072
    s_add_u32 s54, s54, 32768
    s_and_b32 s54, s54, 245760
    buffer_load_dwordx4 v96, s[12:15], s54 offen offset:2048 sc1 lds
    s_waitcnt lgkmcnt(3)
    v_mfma_f32_32x32x16_bf16 v[48:63], v[68:71], v[84:87], v[48:63]
    ds_read_b128 v[68:71], v5 offset:17408
    buffer_load_dwordx4 v96, s[12:15], s54 offen offset:3072 sc1 lds
    s_waitcnt lgkmcnt(3)
    v_smfmac_f32_32x32x32_bf16 v[16:31], v[72:75], v[32:39], v7
    ds_read_b128 v[72:75], v5 offset:6144
    s_waitcnt lgkmcnt(3)
    v_smfmac_f32_32x32x32_bf16 v[16:31], v[76:79], v[40:47], v7
    ds_read_b128 v[76:79], v5 offset:7168
    s_setprio 0
    v_exp_f32 v48, v48
    v_exp_f32 v49, v49
    v_exp_f32 v50, v50
    v_exp_f32 v51, v51
    v_exp_f32 v52, v52
    v_exp_f32 v53, v53
    v_exp_f32 v54, v54
    v_exp_f32 v55, v55
    s_setprio 1
    v_exp_f32 v56, v56
    v_exp_f32 v57, v57
    v_exp_f32 v58, v58
    v_exp_f32 v59, v59
    v_exp_f32 v60, v60
    v_exp_f32 v61, v61
    v_exp_f32 v62, v62
    v_exp_f32 v63, v63
    s_setprio 2
    s_waitcnt lgkmcnt(3)
    v_mfma_f32_32x32x16_bf16 v[32:47], v[64:67], v[80:83], 0
    ds_read_b128 v[64:67], v5 offset:20480
    s_waitcnt lgkmcnt(3)
    v_mfma_f32_32x32x16_bf16 v[32:47], v[68:71], v[84:87], v[32:47]
    ds_read_b128 v[68:71], v5 offset:21504
    s_waitcnt lgkmcnt(3)
    v_smfmac_f32_32x32x32_bf16 v[16:31], v[72:75], v[48:55], v7
    ds_read_b128 v[72:75], v5 offset:18432
    s_waitcnt lgkmcnt(3)
    v_smfmac_f32_32x32x32_bf16 v[16:31], v[76:79], v[56:63], v7
    ds_read_b128 v[76:79], v5 offset:19456
    s_waitcnt vmcnt(6)
    s_barrier
    s_setprio 0
    v_exp_f32 v32, v32
    v_exp_f32 v33, v33
    v_exp_f32 v34, v34
    v_exp_f32 v35, v35
    v_exp_f32 v36, v36
    v_exp_f32 v37, v37
    v_exp_f32 v38, v38
    v_exp_f32 v39, v39
    s_setprio 1
    v_exp_f32 v40, v40
    v_exp_f32 v41, v41
    v_exp_f32 v42, v42
    v_exp_f32 v43, v43
    v_exp_f32 v44, v44
    v_exp_f32 v45, v45
    v_exp_f32 v46, v46
    v_exp_f32 v47, v47
    s_setprio 2
    s_waitcnt lgkmcnt(3)
    v_mfma_f32_32x32x16_bf16 v[48:63], v[64:67], v[80:83], 0
    ds_read_b128 v[64:67], v5 offset:32768
    s_waitcnt vmcnt(4)
    ds_read_b64_tr_b16 v[100:101], v91 offset:0
    ds_read_b64_tr_b16 v[102:103], v92 offset:1024
    ds_read_b64_tr_b16 v[104:105], v91 offset:64
    ds_read_b64_tr_b16 v[106:107], v92 offset:1088
    s_waitcnt lgkmcnt(7)
    v_mfma_f32_32x32x16_bf16 v[48:63], v[68:71], v[84:87], v[48:63]
    ds_read_b128 v[68:71], v5 offset:33792
    s_add_u32 m0, s71, 49152
    s_add_u32 s28, s70, 688128
    buffer_load_dwordx4 v89, s[20:23], s28 offen offset:0 lds
    s_waitcnt lgkmcnt(7)
    v_smfmac_f32_32x32x32_bf16 v[16:31], v[72:75], v[32:39], v7
    ds_read_b128 v[72:75], v5 offset:22528
    s_add_u32 s28, s70, 701440
    buffer_load_dwordx4 v88, s[20:23], s28 offen offset:1024 lds
    s_waitcnt lgkmcnt(7)
    v_smfmac_f32_32x32x32_bf16 v[16:31], v[76:79], v[40:47], v7
    ds_read_b128 v[76:79], v5 offset:23552
    s_setprio 0
    v_exp_f32 v48, v48
    v_exp_f32 v49, v49
    v_exp_f32 v50, v50
    v_exp_f32 v51, v51
    v_exp_f32 v52, v52
    v_exp_f32 v53, v53
    v_exp_f32 v54, v54
    v_exp_f32 v55, v55
    s_setprio 1
    v_exp_f32 v56, v56
    v_exp_f32 v57, v57
    v_exp_f32 v58, v58
    v_exp_f32 v59, v59
    v_exp_f32 v60, v60
    v_exp_f32 v61, v61
    v_exp_f32 v62, v62
    v_exp_f32 v63, v63
    s_setprio 2
    s_waitcnt lgkmcnt(7)
    v_mfma_f32_32x32x16_bf16 v[32:47], v[64:67], v[80:83], 0
    ds_read_b128 v[64:67], v5 offset:36864
    s_waitcnt lgkmcnt(4)
    v_and_b32 v103, s63, v103
    buffer_store_dwordx4 v[100:103], v1, s[12:15], s78 offen sc1
    s_waitcnt lgkmcnt(3)
    v_mfma_f32_32x32x16_bf16 v[32:47], v[68:71], v[84:87], v[32:47]
    ds_read_b128 v[68:71], v5 offset:37888
    v_and_b32 v107, s63, v107
    buffer_store_dwordx4 v[104:107], v1, s[12:15], s55 offen sc1
    s_waitcnt lgkmcnt(3)
    v_smfmac_f32_32x32x32_bf16 v[16:31], v[72:75], v[48:55], v7
    ds_read_b128 v[72:75], v5 offset:34816
    s_waitcnt lgkmcnt(3)
    v_smfmac_f32_32x32x32_bf16 v[16:31], v[76:79], v[56:63], v7
    ds_read_b128 v[76:79], v5 offset:35840
    s_barrier
    s_setprio 0
    v_exp_f32 v32, v32
    v_exp_f32 v33, v33
    v_exp_f32 v34, v34
    v_exp_f32 v35, v35
    v_exp_f32 v36, v36
    v_exp_f32 v37, v37
    v_exp_f32 v38, v38
    v_exp_f32 v39, v39
    s_setprio 1
    v_exp_f32 v40, v40
    v_exp_f32 v41, v41
    v_exp_f32 v42, v42
    v_exp_f32 v43, v43
    v_exp_f32 v44, v44
    v_exp_f32 v45, v45
    v_exp_f32 v46, v46
    v_exp_f32 v47, v47
    s_setprio 2
    s_waitcnt lgkmcnt(3)
    v_mfma_f32_32x32x16_bf16 v[48:63], v[64:67], v[80:83], 0
    ds_read_b128 v[64:67], v5 offset:49152
    s_add_u32 s28, s70, 714752
    buffer_load_dwordx4 v89, s[20:23], s28 offen offset:2048 lds
    s_waitcnt lgkmcnt(3)
    v_mfma_f32_32x32x16_bf16 v[48:63], v[68:71], v[84:87], v[48:63]
    ds_read_b128 v[68:71], v5 offset:50176
    s_add_u32 s28, s70, 728064
    buffer_load_dwordx4 v88, s[20:23], s28 offen offset:3072 lds
    s_waitcnt lgkmcnt(3)
    v_smfmac_f32_32x32x32_bf16 v[16:31], v[72:75], v[32:39], v7
    ds_read_b128 v[72:75], v5 offset:38912
    s_waitcnt lgkmcnt(3)
    v_smfmac_f32_32x32x32_bf16 v[16:31], v[76:79], v[40:47], v7
    ds_read_b128 v[76:79], v5 offset:39936
    s_setprio 0
    v_exp_f32 v48, v48
    v_exp_f32 v49, v49
    v_exp_f32 v50, v50
    v_exp_f32 v51, v51
    v_exp_f32 v52, v52
    v_exp_f32 v53, v53
    v_exp_f32 v54, v54
    v_exp_f32 v55, v55
    s_setprio 1
    v_exp_f32 v56, v56
    v_exp_f32 v57, v57
    v_exp_f32 v58, v58
    v_exp_f32 v59, v59
    v_exp_f32 v60, v60
    v_exp_f32 v61, v61
    v_exp_f32 v62, v62
    v_exp_f32 v63, v63
    s_setprio 2
    s_waitcnt lgkmcnt(3)
    v_mfma_f32_32x32x16_bf16 v[32:47], v[64:67], v[80:83], 0
    ds_read_b128 v[64:67], v5 offset:53248
    s_add_u32 m0, s71, 65536
    s_add_u32 s28, s70, 917504
    buffer_load_dwordx4 v89, s[20:23], s28 offen offset:0 lds
    s_waitcnt lgkmcnt(3)
    v_mfma_f32_32x32x16_bf16 v[32:47], v[68:71], v[84:87], v[32:47]
    ds_read_b128 v[68:71], v5 offset:54272
    s_add_u32 s28, s70, 930816
    buffer_load_dwordx4 v88, s[20:23], s28 offen offset:1024 lds
    s_waitcnt lgkmcnt(3)
    v_smfmac_f32_32x32x32_bf16 v[16:31], v[72:75], v[48:55], v7
    ds_read_b128 v[72:75], v5 offset:51200
    s_waitcnt lgkmcnt(3)
    v_smfmac_f32_32x32x32_bf16 v[16:31], v[76:79], v[56:63], v7
    ds_read_b128 v[76:79], v5 offset:52224
    s_waitcnt vmcnt(4)
    s_barrier
    s_setprio 0
    v_exp_f32 v32, v32
    v_exp_f32 v33, v33
    v_exp_f32 v34, v34
    v_exp_f32 v35, v35
    v_exp_f32 v36, v36
    v_exp_f32 v37, v37
    v_exp_f32 v38, v38
    v_exp_f32 v39, v39
    s_setprio 1
    v_exp_f32 v40, v40
    v_exp_f32 v41, v41
    v_exp_f32 v42, v42
    v_exp_f32 v43, v43
    v_exp_f32 v44, v44
    v_exp_f32 v45, v45
    v_exp_f32 v46, v46
    v_exp_f32 v47, v47
    s_setprio 2
    s_waitcnt lgkmcnt(3)
    v_mfma_f32_32x32x16_bf16 v[48:63], v[64:67], v[80:83], 0
    ds_read_b128 v[64:67], v6 offset:0
    s_add_u32 s28, s70, 944128
    buffer_load_dwordx4 v89, s[20:23], s28 offen offset:2048 lds
    s_waitcnt lgkmcnt(3)
    v_mfma_f32_32x32x16_bf16 v[48:63], v[68:71], v[84:87], v[48:63]
    ds_read_b128 v[68:71], v6 offset:1024
    s_add_u32 s28, s70, 957440
    buffer_load_dwordx4 v88, s[20:23], s28 offen offset:3072 lds
    s_waitcnt lgkmcnt(3)
    v_smfmac_f32_32x32x32_bf16 v[16:31], v[72:75], v[32:39], v7
    ds_read_b128 v[72:75], v5 offset:55296
    s_waitcnt lgkmcnt(3)
    v_smfmac_f32_32x32x32_bf16 v[16:31], v[76:79], v[40:47], v7
    ds_read_b128 v[76:79], v5 offset:56320
    s_setprio 0
    v_exp_f32 v48, v48
    v_exp_f32 v49, v49
    v_exp_f32 v50, v50
    v_exp_f32 v51, v51
    v_exp_f32 v52, v52
    v_exp_f32 v53, v53
    v_exp_f32 v54, v54
    v_exp_f32 v55, v55
    s_setprio 1
    v_exp_f32 v56, v56
    v_exp_f32 v57, v57
    v_exp_f32 v58, v58
    v_exp_f32 v59, v59
    v_exp_f32 v60, v60
    v_exp_f32 v61, v61
    v_exp_f32 v62, v62
    v_exp_f32 v63, v63
    s_setprio 2
    s_waitcnt lgkmcnt(3)
    v_mfma_f32_32x32x16_bf16 v[32:47], v[64:67], v[80:83], 0
    ds_read_b128 v[64:67], v6 offset:4096
    s_add_u32 m0, s71, 0
    s_add_u32 s28, s70, 0
    buffer_load_dwordx4 v89, s[20:23], s28 offen offset:0 lds
    s_waitcnt lgkmcnt(3)
    v_mfma_f32_32x32x16_bf16 v[32:47], v[68:71], v[84:87], v[32:47]
    ds_read_b128 v[68:71], v6 offset:5120
    s_add_u32 s28, s70, 13312
    buffer_load_dwordx4 v88, s[20:23], s28 offen offset:1024 lds
    s_waitcnt lgkmcnt(3)
    v_smfmac_f32_32x32x32_bf16 v[16:31], v[72:75], v[48:55], v7
    ds_read_b128 v[72:75], v6 offset:2048
    s_waitcnt lgkmcnt(3)
    v_smfmac_f32_32x32x32_bf16 v[16:31], v[76:79], v[56:63], v7
    ds_read_b128 v[76:79], v6 offset:3072
    s_barrier
    s_setprio 0
    v_exp_f32 v32, v32
    v_exp_f32 v33, v33
    v_exp_f32 v34, v34
    v_exp_f32 v35, v35
    v_exp_f32 v36, v36
    v_exp_f32 v37, v37
    v_exp_f32 v38, v38
    v_exp_f32 v39, v39
    s_setprio 1
    v_exp_f32 v40, v40
    v_exp_f32 v41, v41
    v_exp_f32 v42, v42
    v_exp_f32 v43, v43
    v_exp_f32 v44, v44
    v_exp_f32 v45, v45
    v_exp_f32 v46, v46
    v_exp_f32 v47, v47
    s_setprio 2
    s_waitcnt lgkmcnt(3)
    v_mfma_f32_32x32x16_bf16 v[48:63], v[64:67], v[80:83], 0
    ds_read_b128 v[64:67], v6 offset:16384
    s_add_u32 s28, s70, 26624
    buffer_load_dwordx4 v89, s[20:23], s28 offen offset:2048 lds
    s_waitcnt lgkmcnt(3)
    v_mfma_f32_32x32x16_bf16 v[48:63], v[68:71], v[84:87], v[48:63]
    ds_read_b128 v[68:71], v6 offset:17408
    s_add_u32 s28, s70, 39936
    buffer_load_dwordx4 v88, s[20:23], s28 offen offset:3072 lds
    s_waitcnt lgkmcnt(3)
    v_smfmac_f32_32x32x32_bf16 v[16:31], v[72:75], v[32:39], v7
    ds_read_b128 v[72:75], v6 offset:6144
    s_waitcnt lgkmcnt(3)
    v_smfmac_f32_32x32x32_bf16 v[16:31], v[76:79], v[40:47], v7
    ds_read_b128 v[76:79], v6 offset:7168
    s_setprio 0
    v_exp_f32 v48, v48
    v_exp_f32 v49, v49
    v_exp_f32 v50, v50
    v_exp_f32 v51, v51
    v_exp_f32 v52, v52
    v_exp_f32 v53, v53
    v_exp_f32 v54, v54
    v_exp_f32 v55, v55
    s_setprio 1
    v_exp_f32 v56, v56
    v_exp_f32 v57, v57
    v_exp_f32 v58, v58
    v_exp_f32 v59, v59
    v_exp_f32 v60, v60
    v_exp_f32 v61, v61
    v_exp_f32 v62, v62
    v_exp_f32 v63, v63
    s_setprio 2
    s_waitcnt lgkmcnt(3)
    v_mfma_f32_32x32x16_bf16 v[32:47], v[64:67], v[80:83], 0
    ds_read_b128 v[64:67], v6 offset:20480
    s_add_u32 m0, s71, 16384
    s_add_u32 s28, s70, 229376
    buffer_load_dwordx4 v89, s[20:23], s28 offen offset:0 lds
    s_waitcnt lgkmcnt(3)
    v_mfma_f32_32x32x16_bf16 v[32:47], v[68:71], v[84:87], v[32:47]
    ds_read_b128 v[68:71], v6 offset:21504
    s_add_u32 s28, s70, 242688
    buffer_load_dwordx4 v88, s[20:23], s28 offen offset:1024 lds
    s_waitcnt lgkmcnt(3)
    v_smfmac_f32_32x32x32_bf16 v[16:31], v[72:75], v[48:55], v7
    ds_read_b128 v[72:75], v6 offset:18432
    s_waitcnt lgkmcnt(3)
    v_smfmac_f32_32x32x32_bf16 v[16:31], v[76:79], v[56:63], v7
    ds_read_b128 v[76:79], v6 offset:19456
    s_barrier
    s_setprio 0
    v_exp_f32 v32, v32
    v_exp_f32 v33, v33
    v_exp_f32 v34, v34
    v_exp_f32 v35, v35
    v_exp_f32 v36, v36
    v_exp_f32 v37, v37
    v_exp_f32 v38, v38
    v_exp_f32 v39, v39
    s_setprio 1
    v_exp_f32 v40, v40
    v_exp_f32 v41, v41
    v_exp_f32 v42, v42
    v_exp_f32 v43, v43
    v_exp_f32 v44, v44
    v_exp_f32 v45, v45
    v_exp_f32 v46, v46
    v_exp_f32 v47, v47
    s_setprio 2
    s_waitcnt lgkmcnt(3)
    v_mfma_f32_32x32x16_bf16 v[48:63], v[64:67], v[80:83], 0
    ds_read_b128 v[64:67], v5 offset:16384
    s_add_u32 s28, s70, 256000
    buffer_load_dwordx4 v89, s[20:23], s28 offen offset:2048 lds
    s_waitcnt lgkmcnt(3)
    v_mfma_f32_32x32x16_bf16 v[48:63], v[68:71], v[84:87], v[48:63]
    ds_read_b128 v[68:71], v5 offset:17408
    s_add_u32 s28, s70, 269312
    buffer_load_dwordx4 v88, s[20:23], s28 offen offset:3072 lds
    s_waitcnt lgkmcnt(3)
    v_smfmac_f32_32x32x32_bf16 v[16:31], v[72:75], v[32:39], v7
    ds_read_b128 v[72:75], v6 offset:22528
    s_waitcnt lgkmcnt(3)
    v_smfmac_f32_32x32x32_bf16 v[16:31], v[76:79], v[40:47], v7
    ds_read_b128 v[76:79], v6 offset:23552
    s_setprio 0
    v_exp_f32 v48, v48
    v_exp_f32 v49, v49
    v_exp_f32 v50, v50
    v_exp_f32 v51, v51
    v_exp_f32 v52, v52
    v_exp_f32 v53, v53
    v_exp_f32 v54, v54
    v_exp_f32 v55, v55
    s_setprio 1
    v_exp_f32 v56, v56
    v_exp_f32 v57, v57
    v_exp_f32 v58, v58
    v_exp_f32 v59, v59
    v_exp_f32 v60, v60
    v_exp_f32 v61, v61
    v_exp_f32 v62, v62
    v_exp_f32 v63, v63
    s_setprio 2
    s_waitcnt lgkmcnt(3)
    v_mfma_f32_32x32x16_bf16 v[32:47], v[64:67], v[80:83], 0
    ds_read_b128 v[64:67], v5 offset:20480
    s_add_u32 m0, s71, 32768
    s_add_u32 s28, s70, 458752
    buffer_load_dwordx4 v89, s[20:23], s28 offen offset:0 lds
    s_waitcnt lgkmcnt(3)
    v_mfma_f32_32x32x16_bf16 v[32:47], v[68:71], v[84:87], v[32:47]
    ds_read_b128 v[68:71], v5 offset:21504
    s_add_u32 s28, s70, 472064
    buffer_load_dwordx4 v88, s[20:23], s28 offen offset:1024 lds
    s_waitcnt lgkmcnt(3)
    v_smfmac_f32_32x32x32_bf16 v[16:31], v[72:75], v[48:55], v7
    ds_read_b128 v[72:75], v5 offset:18432
    s_waitcnt lgkmcnt(3)
    v_smfmac_f32_32x32x32_bf16 v[16:31], v[76:79], v[56:63], v7
    ds_read_b128 v[76:79], v5 offset:19456
    s_barrier
    s_setprio 0
    v_exp_f32 v32, v32
    v_exp_f32 v33, v33
    v_exp_f32 v34, v34
    v_exp_f32 v35, v35
    v_exp_f32 v36, v36
    v_exp_f32 v37, v37
    v_exp_f32 v38, v38
    v_exp_f32 v39, v39
    s_setprio 1
    v_exp_f32 v40, v40
    v_exp_f32 v41, v41
    v_exp_f32 v42, v42
    v_exp_f32 v43, v43
    v_exp_f32 v44, v44
    v_exp_f32 v45, v45
    v_exp_f32 v46, v46
    v_exp_f32 v47, v47
    s_setprio 2
    s_waitcnt lgkmcnt(3)
    v_mfma_f32_32x32x16_bf16 v[48:63], v[64:67], v[80:83], 0
    ds_read_b128 v[64:67], v5 offset:32768
    buffer_load_dwordx4 v[8:11], v94, s[12:15], s86 offen sc1
    s_waitcnt lgkmcnt(3)
    v_mfma_f32_32x32x16_bf16 v[48:63], v[68:71], v[84:87], v[48:63]
    ds_read_b128 v[68:71], v5 offset:33792
    s_add_u32 s28, s70, 485376
    buffer_load_dwordx4 v89, s[20:23], s28 offen offset:2048 lds
    s_waitcnt lgkmcnt(3)
    v_smfmac_f32_32x32x32_bf16 v[16:31], v[72:75], v[32:39], v7
    ds_read_b128 v[72:75], v5 offset:22528
    s_waitcnt lgkmcnt(3)
    v_smfmac_f32_32x32x32_bf16 v[16:31], v[76:79], v[40:47], v7
    ds_read_b128 v[76:79], v5 offset:23552
    s_setprio 0
    v_exp_f32 v48, v48
    v_exp_f32 v49, v49
    v_exp_f32 v50, v50
    v_exp_f32 v51, v51
    v_exp_f32 v52, v52
    v_exp_f32 v53, v53
    v_exp_f32 v54, v54
    v_exp_f32 v55, v55
    s_setprio 1
    v_exp_f32 v56, v56
    v_exp_f32 v57, v57
    v_exp_f32 v58, v58
    v_exp_f32 v59, v59
    v_exp_f32 v60, v60
    v_exp_f32 v61, v61
    v_exp_f32 v62, v62
    v_exp_f32 v63, v63
    s_setprio 2
    s_waitcnt lgkmcnt(3)
    v_mfma_f32_32x32x16_bf16 v[32:47], v[64:67], v[80:83], 0
    ds_read_b128 v[64:67], v5 offset:36864
    s_add_u32 s28, s70, 498688
    buffer_load_dwordx4 v88, s[20:23], s28 offen offset:3072 lds
    s_waitcnt lgkmcnt(3)
    v_mfma_f32_32x32x16_bf16 v[32:47], v[68:71], v[84:87], v[32:47]
    ds_read_b128 v[68:71], v5 offset:37888
    s_waitcnt lgkmcnt(3)
    v_smfmac_f32_32x32x32_bf16 v[16:31], v[72:75], v[48:55], v7
    ds_read_b128 v[72:75], v5 offset:34816
    s_waitcnt lgkmcnt(3)
    v_smfmac_f32_32x32x32_bf16 v[16:31], v[76:79], v[56:63], v7
    ds_read_b128 v[76:79], v5 offset:35840
    s_waitcnt vmcnt(2)
Lp0c:
    v_xor_b32 v8, v8, v9
    v_xor_b32 v9, v9, v10
    v_xor_b32 v10, v10, v11
    v_xor_b32 v11, s80, v11
    v_or3_b32 v8, v8, v9, v10
    v_or_b32 v8, v8, v11
    v_cmp_ne_u32 vcc, 0, v8
    s_cbranch_vccnz Lp0r
Lp0d:
    s_barrier
    s_setprio 0
    v_exp_f32 v32, v32
    v_exp_f32 v33, v33
    v_exp_f32 v34, v34
    v_exp_f32 v35, v35
    v_exp_f32 v36, v36
    v_exp_f32 v37, v37
    v_exp_f32 v38, v38
    v_exp_f32 v39, v39
    s_setprio 1
    v_exp_f32 v40, v40
    v_exp_f32 v41, v41
    v_exp_f32 v42, v42
    v_exp_f32 v43, v43
    v_exp_f32 v44, v44
    v_exp_f32 v45, v45
    v_exp_f32 v46, v46
    v_exp_f32 v47, v47
    s_setprio 2
    s_waitcnt lgkmcnt(3)
    v_mfma_f32_32x32x16_bf16 v[48:63], v[64:67], v[80:83], 0
    ds_read_b128 v[64:67], v5 offset:49152
    s_mov_b32 s28, 1572864
    buffer_load_dword v110, v95, s[12:15], s28 offen sc1
    s_waitcnt lgkmcnt(3)
    v_mfma_f32_32x32x16_bf16 v[48:63], v[68:71], v[84:87], v[48:63]
    ds_read_b128 v[68:71], v5 offset:50176
    s_add_u32 m0, s71, 81920
    s_add_u32 s54, s54, 114688
    s_and_b32 s54, s54, 245760
    buffer_load_dwordx4 v96, s[12:15], s54 offen offset:0 sc1 lds
    s_waitcnt lgkmcnt(3)
    v_smfmac_f32_32x32x32_bf16 v[16:31], v[72:75], v[32:39], v7
    ds_read_b128 v[72:75], v5 offset:38912
    s_waitcnt lgkmcnt(3)
    v_smfmac_f32_32x32x32_bf16 v[16:31], v[76:79], v[40:47], v7
    ds_read_b128 v[76:79], v5 offset:39936
    s_setprio 0
    v_exp_f32 v48, v48
    v_exp_f32 v49, v49
    v_exp_f32 v50, v50
    v_exp_f32 v51, v51
    v_exp_f32 v52, v52
    v_exp_f32 v53, v53
    v_exp_f32 v54, v54
    v_exp_f32 v55, v55
    s_setprio 1
    v_exp_f32 v56, v56
    v_exp_f32 v57, v57
    v_exp_f32 v58, v58
    v_exp_f32 v59, v59
    v_exp_f32 v60, v60
    v_exp_f32 v61, v61
    v_exp_f32 v62, v62
    v_exp_f32 v63, v63
    s_setprio 2
    s_waitcnt lgkmcnt(3)
    v_mfma_f32_32x32x16_bf16 v[32:47], v[64:67], v[80:83], 0
    ds_read_b128 v[64:67], v5 offset:53248
    buffer_load_dwordx4 v96, s[12:15], s54 offen offset:1024 sc1 lds
    s_waitcnt lgkmcnt(3)
    v_mfma_f32_32x32x16_bf16 v[32:47], v[68:71], v[84:87], v[32:47]
    ds_read_b128 v[68:71], v5 offset:54272
    buffer_load_dwordx4 v96, s[12:15], s54 offen offset:2048 sc1 lds
    s_waitcnt lgkmcnt(3)
    v_smfmac_f32_32x32x32_bf16 v[16:31], v[72:75], v[48:55], v7
    ds_read_b128 v[72:75], v5 offset:51200
    s_waitcnt lgkmcnt(3)
    v_smfmac_f32_32x32x32_bf16 v[16:31], v[76:79], v[56:63], v7
    ds_read_b128 v[76:79], v5 offset:52224
    s_barrier
    s_setprio 0
    v_exp_f32 v32, v32
    v_exp_f32 v33, v33
    v_exp_f32 v34, v34
    v_exp_f32 v35, v35
    v_exp_f32 v36, v36
    v_exp_f32 v37, v37
    v_exp_f32 v38, v38
    v_exp_f32 v39, v39
    s_setprio 1
    v_exp_f32 v40, v40
    v_exp_f32 v41, v41
    v_exp_f32 v42, v42
    v_exp_f32 v43, v43
    v_exp_f32 v44, v44
    v_exp_f32 v45, v45
    v_exp_f32 v46, v46
    v_exp_f32 v47, v47
    s_setprio 2
    s_waitcnt lgkmcnt(3)
    v_mfma_f32_32x32x16_bf16 v[48:63], v[64:67], v[80:83], 0
    ds_read_b128 v[64:67], v6 offset:0
    buffer_load_dword v110, v111, s[12:15], 0 offen sc1
    s_waitcnt lgkmcnt(3)
    v_mfma_f32_32x32x16_bf16 v[48:63], v[68:71], v[84:87], v[48:63]
    ds_read_b128 v[68:71], v6 offset:1024
    s_add_u32 m0, s71, 98304
    s_add_u32 s54, s54, 16384
    s_and_b32 s54, s54, 245760
    buffer_load_dwordx4 v96, s[12:15], s54 offen offset:0 sc1 lds
    s_waitcnt lgkmcnt(3)
    v_smfmac_f32_32x32x32_bf16 v[16:31], v[72:75], v[32:39], v7
    ds_read_b128 v[72:75], v5 offset:55296
    s_waitcnt lgkmcnt(3)
    v_smfmac_f32_32x32x32_bf16 v[16:31], v[76:79], v[40:47], v7
    ds_read_b128 v[76:79], v5 offset:56320
    s_setprio 0
    v_exp_f32 v48, v48
    v_exp_f32 v49, v49
    v_exp_f32 v50, v50
    v_exp_f32 v51, v51
    v_exp_f32 v52, v52
    v_exp_f32 v53, v53
    v_exp_f32 v54, v54
    v_exp_f32 v55, v55
    s_setprio 1
    v_exp_f32 v56, v56
    v_exp_f32 v57, v57
    v_exp_f32 v58, v58
    v_exp_f32 v59, v59
    v_exp_f32 v60, v60
    v_exp_f32 v61, v61
    v_exp_f32 v62, v62
    v_exp_f32 v63, v63
    s_setprio 2
    s_waitcnt lgkmcnt(3)
    v_mfma_f32_32x32x16_bf16 v[32:47], v[64:67], v[80:83], 0
    ds_read_b128 v[64:67], v6 offset:4096
    s_mov_b32 s28, 1581056
    buffer_load_dword v110, v95, s[12:15], s28 offen sc1
    s_waitcnt lgkmcnt(3)
    v_mfma_f32_32x32x16_bf16 v[32:47], v[68:71], v[84:87], v[32:47]
    ds_read_b128 v[68:71], v6 offset:5120
    buffer_load_dwordx4 v96, s[12:15], s54 offen offset:1024 sc1 lds
    s_waitcnt lgkmcnt(3)
    v_smfmac_f32_32x32x32_bf16 v[16:31], v[72:75], v[48:55], v7
    ds_read_b128 v[72:75], v6 offset:2048
    s_waitcnt lgkmcnt(3)
    v_smfmac_f32_32x32x32_bf16 v[16:31], v[76:79], v[56:63], v7
    ds_read_b128 v[76:79], v6 offset:3072
    s_barrier
    s_setprio 0
    v_exp_f32 v32, v32
    v_exp_f32 v33, v33
    v_exp_f32 v34, v34
    v_exp_f32 v35, v35
    v_exp_f32 v36, v36
    v_exp_f32 v37, v37
    v_exp_f32 v38, v38
    v_exp_f32 v39, v39
    s_setprio 1
    v_exp_f32 v40, v40
    v_exp_f32 v41, v41
    v_exp_f32 v42, v42
    v_exp_f32 v43, v43
    v_exp_f32 v44, v44
    v_exp_f32 v45, v45
    v_exp_f32 v46, v46
    v_exp_f32 v47, v47
    s_setprio 2
    s_waitcnt lgkmcnt(3)
    v_mfma_f32_32x32x16_bf16 v[48:63], v[64:67], v[80:83], 0
    ds_read_b128 v[64:67], v6 offset:16384
    s_add_u32 m0, s71, 114688
    s_add_u32 s54, s54, 16384
    s_and_b32 s54, s54, 245760
    buffer_load_dwordx4 v96, s[12:15], s54 offen offset:0 sc1 lds
    s_waitcnt lgkmcnt(3)
    v_mfma_f32_32x32x16_bf16 v[48:63], v[68:71], v[84:87], v[48:63]
    ds_read_b128 v[68:71], v6 offset:17408
    buffer_load_dwordx4 v96, s[12:15], s54 offen offset:1024 sc1 lds
    s_waitcnt lgkmcnt(3)
    v_smfmac_f32_32x32x32_bf16 v[16:31], v[72:75], v[32:39], v7
    ds_read_b128 v[72:75], v6 offset:6144
    s_waitcnt lgkmcnt(3)
    v_smfmac_f32_32x32x32_bf16 v[16:31], v[76:79], v[40:47], v7
    ds_read_b128 v[76:79], v6 offset:7168
    s_setprio 0
    v_exp_f32 v48, v48
    v_exp_f32 v49, v49
    v_exp_f32 v50, v50
    v_exp_f32 v51, v51
    v_exp_f32 v52, v52
    v_exp_f32 v53, v53
    v_exp_f32 v54, v54
    v_exp_f32 v55, v55
    s_setprio 1
    v_exp_f32 v56, v56
    v_exp_f32 v57, v57
    v_exp_f32 v58, v58
    v_exp_f32 v59, v59
    v_exp_f32 v60, v60
    v_exp_f32 v61, v61
    v_exp_f32 v62, v62
    v_exp_f32 v63, v63
    s_setprio 2
    s_waitcnt lgkmcnt(3)
    v_mfma_f32_32x32x16_bf16 v[32:47], v[64:67], v[80:83], 0
    ds_read_b128 v[64:67], v6 offset:20480
    s_mov_b32 s28, 1589248
    buffer_load_dword v110, v95, s[12:15], s28 offen sc1
    s_waitcnt lgkmcnt(3)
    v_mfma_f32_32x32x16_bf16 v[32:47], v[68:71], v[84:87], v[32:47]
    ds_read_b128 v[68:71], v6 offset:21504
    buffer_load_dwordx4 v96, s[12:15], s54 offen offset:2048 sc1 lds
    s_waitcnt lgkmcnt(3)
    v_smfmac_f32_32x32x32_bf16 v[16:31], v[72:75], v[48:55], v7
    ds_read_b128 v[72:75], v6 offset:18432
    s_waitcnt lgkmcnt(3)
    v_smfmac_f32_32x32x32_bf16 v[16:31], v[76:79], v[56:63], v7
    ds_read_b128 v[76:79], v6 offset:19456
    s_waitcnt vmcnt(8)
    s_barrier
    s_setprio 0
    v_exp_f32 v32, v32
    v_exp_f32 v33, v33
    v_exp_f32 v34, v34
    v_exp_f32 v35, v35
    v_exp_f32 v36, v36
    v_exp_f32 v37, v37
    v_exp_f32 v38, v38
    v_exp_f32 v39, v39
    s_setprio 1
    v_exp_f32 v40, v40
    v_exp_f32 v41, v41
    v_exp_f32 v42, v42
    v_exp_f32 v43, v43
    v_exp_f32 v44, v44
    v_exp_f32 v45, v45
    v_exp_f32 v46, v46
    v_exp_f32 v47, v47
    s_setprio 2
    s_waitcnt lgkmcnt(3)
    v_mfma_f32_32x32x16_bf16 v[48:63], v[64:67], v[80:83], 0
    ds_read_b128 v[64:67], v5 offset:16384
    s_mov_b32 s28, 1597440
    buffer_load_dword v110, v95, s[12:15], s28 offen sc1
    s_waitcnt lgkmcnt(3)
    v_mfma_f32_32x32x16_bf16 v[48:63], v[68:71], v[84:87], v[48:63]
    ds_read_b128 v[68:71], v5 offset:17408
    s_add_u32 m0, s71, 131072
    s_add_u32 s54, s54, 16384
    s_and_b32 s54, s54, 245760
    buffer_load_dwordx4 v96, s[12:15], s54 offen offset:0 sc1 lds
    s_waitcnt lgkmcnt(3)
    v_smfmac_f32_32x32x32_bf16 v[16:31], v[72:75], v[32:39], v7
    ds_read_b128 v[72:75], v6 offset:22528
    s_waitcnt lgkmcnt(3)
    v_smfmac_f32_32x32x32_bf16 v[16:31], v[76:79], v[40:47], v7
    ds_read_b128 v[76:79], v6 offset:23552
    s_setprio 0
    v_exp_f32 v48, v48
    v_exp_f32 v49, v49
    v_exp_f32 v50, v50
    v_exp_f32 v51, v51
    v_exp_f32 v52, v52
    v_exp_f32 v53, v53
    v_exp_f32 v54, v54
    v_exp_f32 v55, v55
    s_setprio 1
    v_exp_f32 v56, v56
    v_exp_f32 v57, v57
    v_exp_f32 v58, v58
    v_exp_f32 v59, v59
    v_exp_f32 v60, v60
    v_exp_f32 v61, v61
    v_exp_f32 v62, v62
    v_exp_f32 v63, v63
    s_setprio 2
    s_waitcnt lgkmcnt(3)
    v_mfma_f32_32x32x16_bf16 v[32:47], v[64:67], v[80:83], 0
    ds_read_b128 v[64:67], v5 offset:20480
    buffer_load_dwordx4 v96, s[12:15], s54 offen offset:1024 sc1 lds
    s_waitcnt lgkmcnt(3)
    v_mfma_f32_32x32x16_bf16 v[32:47], v[68:71], v[84:87], v[32:47]
    ds_read_b128 v[68:71], v5 offset:21504
    buffer_load_dwordx4 v96, s[12:15], s54 offen offset:2048 sc1 lds
    s_waitcnt lgkmcnt(3)
    v_smfmac_f32_32x32x32_bf16 v[16:31], v[72:75], v[48:55], v7
    ds_read_b128 v[72:75], v5 offset:18432
    s_waitcnt lgkmcnt(3)
    v_smfmac_f32_32x32x32_bf16 v[16:31], v[76:79], v[56:63], v7
    ds_read_b128 v[76:79], v5 offset:19456
    s_waitcnt vmcnt(8)
    s_barrier
    s_setprio 0
    v_exp_f32 v32, v32
    v_exp_f32 v33, v33
    v_exp_f32 v34, v34
    v_exp_f32 v35, v35
    v_exp_f32 v36, v36
    v_exp_f32 v37, v37
    v_exp_f32 v38, v38
    v_exp_f32 v39, v39
    s_setprio 1
    v_exp_f32 v40, v40
    v_exp_f32 v41, v41
    v_exp_f32 v42, v42
    v_exp_f32 v43, v43
    v_exp_f32 v44, v44
    v_exp_f32 v45, v45
    v_exp_f32 v46, v46
    v_exp_f32 v47, v47
    s_setprio 2
    s_waitcnt lgkmcnt(3)
    v_mfma_f32_32x32x16_bf16 v[48:63], v[64:67], v[80:83], 0
    ds_read_b128 v[64:67], v5 offset:32768
    s_mov_b32 s28, 1605632
    buffer_load_dword v110, v95, s[12:15], s28 offen sc1
    s_waitcnt lgkmcnt(3)
    v_mfma_f32_32x32x16_bf16 v[48:63], v[68:71], v[84:87], v[48:63]
    ds_read_b128 v[68:71], v5 offset:33792
    s_waitcnt lgkmcnt(3)
    v_smfmac_f32_32x32x32_bf16 v[16:31], v[72:75], v[32:39], v7
    ds_read_b128 v[72:75], v5 offset:22528
    s_waitcnt lgkmcnt(3)
    v_smfmac_f32_32x32x32_bf16 v[16:31], v[76:79], v[40:47], v7
    ds_read_b128 v[76:79], v5 offset:23552
    s_setprio 0
    v_exp_f32 v48, v48
    v_exp_f32 v49, v49
    v_exp_f32 v50, v50
    v_exp_f32 v51, v51
    v_exp_f32 v52, v52
    v_exp_f32 v53, v53
    v_exp_f32 v54, v54
    v_exp_f32 v55, v55
    s_setprio 1
    v_exp_f32 v56, v56
    v_exp_f32 v57, v57
    v_exp_f32 v58, v58
    v_exp_f32 v59, v59
    v_exp_f32 v60, v60
    v_exp_f32 v61, v61
    v_exp_f32 v62, v62
    v_exp_f32 v63, v63
    s_setprio 2
    s_waitcnt lgkmcnt(3)
    v_mfma_f32_32x32x16_bf16 v[32:47], v[64:67], v[80:83], 0
    ds_read_b128 v[64:67], v5 offset:36864
    s_mov_b32 s28, 1613824
    buffer_load_dword v110, v95, s[12:15], s28 offen sc1
    s_waitcnt lgkmcnt(3)
    v_mfma_f32_32x32x16_bf16 v[32:47], v[68:71], v[84:87], v[32:47]
    ds_read_b128 v[68:71], v5 offset:37888
    s_waitcnt lgkmcnt(3)
    v_smfmac_f32_32x32x32_bf16 v[16:31], v[72:75], v[48:55], v7
    ds_read_b128 v[72:75], v5 offset:34816
    s_waitcnt lgkmcnt(3)
    v_smfmac_f32_32x32x32_bf16 v[16:31], v[76:79], v[56:63], v7
    ds_read_b128 v[76:79], v5 offset:35840
    s_waitcnt vmcnt(6)
    s_barrier
    s_setprio 0
    v_exp_f32 v32, v32
    v_exp_f32 v33, v33
    v_exp_f32 v34, v34
    v_exp_f32 v35, v35
    v_exp_f32 v36, v36
    v_exp_f32 v37, v37
    v_exp_f32 v38, v38
    v_exp_f32 v39, v39
    s_setprio 1
    v_exp_f32 v40, v40
    v_exp_f32 v41, v41
    v_exp_f32 v42, v42
    v_exp_f32 v43, v43
    v_exp_f32 v44, v44
    v_exp_f32 v45, v45
    v_exp_f32 v46, v46
    v_exp_f32 v47, v47
    s_setprio 2
    s_waitcnt lgkmcnt(3)
    v_mfma_f32_32x32x16_bf16 v[48:63], v[64:67], v[80:83], 0
    ds_read_b128 v[64:67], v5 offset:49152
    s_add_u32 m0, s71, 81920
    s_add_u32 s28, s70, 1146880
    buffer_load_dwordx4 v89, s[20:23], s28 offen offset:0 lds
    s_waitcnt lgkmcnt(3)
    v_mfma_f32_32x32x16_bf16 v[48:63], v[68:71], v[84:87], v[48:63]
    ds_read_b128 v[68:71], v5 offset:50176
    s_add_u32 s28, s70, 1160192
    buffer_load_dwordx4 v88, s[20:23], s28 offen offset:1024 lds
    s_waitcnt lgkmcnt(3)
    v_smfmac_f32_32x32x32_bf16 v[16:31], v[72:75], v[32:39], v7
    ds_read_b128 v[72:75], v5 offset:38912
    s_waitcnt lgkmcnt(3)
    v_smfmac_f32_32x32x32_bf16 v[16:31], v[76:79], v[40:47], v7
    ds_read_b128 v[76:79], v5 offset:39936
    s_setprio 0
    v_exp_f32 v48, v48
    v_exp_f32 v49, v49
    v_exp_f32 v50, v50
    v_exp_f32 v51, v51
    v_exp_f32 v52, v52
    v_exp_f32 v53, v53
    v_exp_f32 v54, v54
    v_exp_f32 v55, v55
    s_setprio 1
    v_exp_f32 v56, v56
    v_exp_f32 v57, v57
    v_exp_f32 v58, v58
    v_exp_f32 v59, v59
    v_exp_f32 v60, v60
    v_exp_f32 v61, v61
    v_exp_f32 v62, v62
    v_exp_f32 v63, v63
    s_setprio 2
    s_waitcnt lgkmcnt(3)
    v_mfma_f32_32x32x16_bf16 v[32:47], v[64:67], v[80:83], 0
    ds_read_b128 v[64:67], v5 offset:53248
    s_add_u32 s28, s70, 1173504
    buffer_load_dwordx4 v89, s[20:23], s28 offen offset:2048 lds
    s_waitcnt lgkmcnt(3)
    v_mfma_f32_32x32x16_bf16 v[32:47], v[68:71], v[84:87], v[32:47]
    ds_read_b128 v[68:71], v5 offset:54272
    s_add_u32 s28, s70, 1186816
    buffer_load_dwordx4 v88, s[20:23], s28 offen offset:3072 lds
    s_waitcnt lgkmcnt(3)
    v_smfmac_f32_32x32x32_bf16 v[16:31], v[72:75], v[48:55], v7
    ds_read_b128 v[72:75], v5 offset:51200
    s_waitcnt lgkmcnt(3)
    v_smfmac_f32_32x32x32_bf16 v[16:31], v[76:79], v[56:63], v7
    ds_read_b128 v[76:79], v5 offset:52224
    s_waitcnt vmcnt(6)
    s_barrier
    s_setprio 0
    v_exp_f32 v32, v32
    v_exp_f32 v33, v33
    v_exp_f32 v34, v34
    v_exp_f32 v35, v35
    v_exp_f32 v36, v36
    v_exp_f32 v37, v37
    v_exp_f32 v38, v38
    v_exp_f32 v39, v39
    s_setprio 1
    v_exp_f32 v40, v40
    v_exp_f32 v41, v41
    v_exp_f32 v42, v42
    v_exp_f32 v43, v43
    v_exp_f32 v44, v44
    v_exp_f32 v45, v45
    v_exp_f32 v46, v46
    v_exp_f32 v47, v47
    s_setprio 2
    s_waitcnt lgkmcnt(3)
    v_mfma_f32_32x32x16_bf16 v[48:63], v[64:67], v[80:83], 0
    ds_read_b128 v[64:67], v6 offset:0
    s_add_u32 m0, s71, 98304
    s_add_u32 s28, s70, 1376256
    buffer_load_dwordx4 v89, s[20:23], s28 offen offset:0 lds
    s_waitcnt lgkmcnt(3)
    v_mfma_f32_32x32x16_bf16 v[48:63], v[68:71], v[84:87], v[48:63]
    ds_read_b128 v[68:71], v6 offset:1024
    s_add_u32 s28, s70, 1389568
    buffer_load_dwordx4 v88, s[20:23], s28 offen offset:1024 lds
    s_waitcnt lgkmcnt(3)
    v_smfmac_f32_32x32x32_bf16 v[16:31], v[72:75], v[32:39], v7
    ds_read_b128 v[72:75], v5 offset:55296
    s_waitcnt lgkmcnt(3)
    v_smfmac_f32_32x32x32_bf16 v[16:31], v[76:79], v[40:47], v7
    ds_read_b128 v[76:79], v5 offset:56320
    s_setprio 0
    v_exp_f32 v48, v48
    v_exp_f32 v49, v49
    v_exp_f32 v50, v50
    v_exp_f32 v51, v51
    v_exp_f32 v52, v52
    v_exp_f32 v53, v53
    v_exp_f32 v54, v54
    v_exp_f32 v55, v55
    s_setprio 1
    v_exp_f32 v56, v56
    v_exp_f32 v57, v57
    v_exp_f32 v58, v58
    v_exp_f32 v59, v59
    v_exp_f32 v60, v60
    v_exp_f32 v61, v61
    v_exp_f32 v62, v62
    v_exp_f32 v63, v63
    s_setprio 2
    s_waitcnt lgkmcnt(3)
    v_mfma_f32_32x32x16_bf16 v[32:47], v[64:67], v[80:83], 0
    ds_read_b128 v[64:67], v6 offset:4096
    s_add_u32 s28, s70, 1402880
    buffer_load_dwordx4 v89, s[20:23], s28 offen offset:2048 lds
    s_waitcnt lgkmcnt(3)
    v_mfma_f32_32x32x16_bf16 v[32:47], v[68:71], v[84:87], v[32:47]
    ds_read_b128 v[68:71], v6 offset:5120
    s_add_u32 s28, s70, 1416192
    buffer_load_dwordx4 v88, s[20:23], s28 offen offset:3072 lds
    s_waitcnt lgkmcnt(3)
    v_smfmac_f32_32x32x32_bf16 v[16:31], v[72:75], v[48:55], v7
    ds_read_b128 v[72:75], v6 offset:2048
    s_waitcnt lgkmcnt(3)
    v_smfmac_f32_32x32x32_bf16 v[16:31], v[76:79], v[56:63], v7
    ds_read_b128 v[76:79], v6 offset:3072
    s_setprio 0
    v_exp_f32 v32, v32
    v_exp_f32 v33, v33
    v_exp_f32 v34, v34
    v_exp_f32 v35, v35
    v_exp_f32 v36, v36
    v_exp_f32 v37, v37
    v_exp_f32 v38, v38
    v_exp_f32 v39, v39
    s_setprio 1
    v_exp_f32 v40, v40
    v_exp_f32 v41, v41
    v_exp_f32 v42, v42
    v_exp_f32 v43, v43
    v_exp_f32 v44, v44
    v_exp_f32 v45, v45
    v_exp_f32 v46, v46
    v_exp_f32 v47, v47
    s_setprio 2
    s_waitcnt lgkmcnt(3)
    v_mfma_f32_32x32x16_bf16 v[48:63], v[64:67], v[80:83], 0
    buffer_load_dwordx4 v[128:131], v14, s[12:15], s95 offen offset:0 sc1
    s_waitcnt lgkmcnt(2)
    v_mfma_f32_32x32x16_bf16 v[48:63], v[68:71], v[84:87], v[48:63]
    buffer_load_dwordx4 v[132:135], v14, s[12:15], s95 offen offset:256 sc1
    s_waitcnt lgkmcnt(1)
    v_smfmac_f32_32x32x32_bf16 v[16:31], v[72:75], v[32:39], v7
    ds_read_b128 v[72:75], v6 offset:6144
    s_waitcnt lgkmcnt(1)
    v_smfmac_f32_32x32x32_bf16 v[16:31], v[76:79], v[40:47], v7
    ds_read_b128 v[76:79], v6 offset:7168
    s_setprio 0
    v_exp_f32 v48, v48
    v_exp_f32 v49, v49
    v_exp_f32 v50, v50
    v_exp_f32 v51, v51
    v_exp_f32 v52, v52
    v_exp_f32 v53, v53
    v_exp_f32 v54, v54
    v_exp_f32 v55, v55
    s_setprio 1
    v_exp_f32 v56, v56
    v_exp_f32 v57, v57
    v_exp_f32 v58, v58
    v_exp_f32 v59, v59
    v_exp_f32 v60, v60
    v_exp_f32 v61, v61
    v_exp_f32 v62, v62
    v_exp_f32 v63, v63
    s_setprio 2
    buffer_load_dwordx4 v[136:139], v14, s[12:15], s95 offen offset:2048 sc1
    buffer_load_dwordx4 v[140:143], v14, s[12:15], s95 offen offset:2304 sc1
    s_add_u32 s95, s95, 4096
    s_waitcnt lgkmcnt(1)
    v_smfmac_f32_32x32x32_bf16 v[16:31], v[72:75], v[48:55], v7
    s_waitcnt lgkmcnt(0)
    v_smfmac_f32_32x32x32_bf16 v[16:31], v[76:79], v[56:63], v7
    s_setprio 3
    s_barrier
    ds_read_b128 v[36:39], v3 offset:1024
    ds_read_b128 v[32:35], v3 offset:0
    ds_read_b128 v[40:43], v3 offset:2048
    ds_read_b128 v[44:47], v3 offset:3072
    s_waitcnt lgkmcnt(3)
    s_nop 4
    v_pk_add_f32 v[22:23], v[22:23], v[38:39]
    v_pk_add_f32 v[20:21], v[20:21], v[36:37]
    v_cmp_ngt_f32 vcc, s32, v23
    v_cmp_nlt_f32 s[82:83], s33, v23
    s_waitcnt lgkmcnt(2)
    v_pk_add_f32 v[18:19], v[18:19], v[34:35]
    v_pk_add_f32 v[16:17], v[16:17], v[32:33]
    s_waitcnt lgkmcnt(1)
    v_pk_add_f32 v[26:27], v[26:27], v[42:43]
    v_pk_add_f32 v[24:25], v[24:25], v[40:41]
    s_waitcnt lgkmcnt(0)
    v_pk_add_f32 v[30:31], v[30:31], v[46:47]
    v_pk_add_f32 v[28:29], v[28:29], v[44:45]
    s_or_b64 vcc, vcc, s[82:83]
    s_cbranch_scc1 Lfb
Lfbd:
    v_rcp_f32 v5, v23
    s_nop 0
    v_pk_mul_f32 v[16:17], v[16:17], v[4:5] op_sel:[0,1] op_sel_hi:[1,1]
    v_pk_mul_f32 v[18:19], v[18:19], v[4:5] op_sel:[0,1] op_sel_hi:[1,1]
    v_pk_mul_f32 v[20:21], v[20:21], v[4:5] op_sel:[0,1] op_sel_hi:[1,1]
    v_pk_mul_f32 v[22:23], v[22:23], v[4:5] op_sel:[0,1] op_sel_hi:[1,1]
    v_cvt_pk_bf16_f32 v32, v16, v17
    v_cvt_pk_bf16_f32 v33, v18, v19
    v_cvt_pk_bf16_f32 v34, v20, v21
    v_cvt_pk_bf16_f32 v35, v22, v109
    buffer_store_dwordx4 v[32:35], v1, s[12:15], s31 offen offset:0 sc1
    v_pk_mul_f32 v[24:25], v[24:25], v[4:5] op_sel:[0,1] op_sel_hi:[1,1]
    v_pk_mul_f32 v[26:27], v[26:27], v[4:5] op_sel:[0,1] op_sel_hi:[1,1]
    v_pk_mul_f32 v[28:29], v[28:29], v[4:5] op_sel:[0,1] op_sel_hi:[1,1]
    v_pk_mul_f32 v[30:31], v[30:31], v[4:5] op_sel:[0,1] op_sel_hi:[1,1]
    v_cvt_pk_bf16_f32 v36, v24, v25
    v_cvt_pk_bf16_f32 v37, v26, v27
    v_cvt_pk_bf16_f32 v38, v28, v29
    v_cvt_pk_bf16_f32 v39, v30, v109
    buffer_store_dwordx4 v[36:39], v1, s[12:15], s31 offen offset:1024 sc1
    s_cmp_ge_u32 s5, 28
    s_waitcnt vmcnt(6)
    s_setprio 0
    s_cbranch_scc1 LB_idle
    buffer_load_dwordx4 v[144:147], v14, s[12:15], s95 offen offset:0 sc1
    buffer_load_dwordx4 v[148:151], v14, s[12:15], s95 offen offset:256 sc1
    buffer_load_dwordx4 v[152:155], v14, s[12:15], s95 offen offset:2048 sc1
    buffer_load_dwordx4 v[156:159], v14, s[12:15], s95 offen offset:2304 sc1
    s_add_u32 s95, s95, 4096
    buffer_load_dwordx4 v[160:163], v14, s[12:15], s95 offen offset:0 sc1
    buffer_load_dwordx4 v[164:167], v14, s[12:15], s95 offen offset:256 sc1
    buffer_load_dwordx4 v[168:171], v14, s[12:15], s95 offen offset:2048 sc1
    buffer_load_dwordx4 v[172:175], v14, s[12:15], s95 offen offset:2304 sc1
    s_add_u32 s95, s95, 4096
    buffer_load_dwordx4 v[176:179], v14, s[12:15], s95 offen offset:0 sc1
    buffer_load_dwordx4 v[180:183], v14, s[12:15], s95 offen offset:256 sc1
    buffer_load_dwordx4 v[184:187], v14, s[12:15], s95 offen offset:2048 sc1
    buffer_load_dwordx4 v[188:191], v14, s[12:15], s95 offen offset:2304 sc1
    s_add_u32 s95, s95, 4096
    buffer_load_dwordx4 v[192:195], v14, s[12:15], s95 offen offset:0 sc1
    buffer_load_dwordx4 v[196:199], v14, s[12:15], s95 offen offset:256 sc1
    buffer_load_dwordx4 v[200:203], v14, s[12:15], s95 offen offset:2048 sc1
    buffer_load_dwordx4 v[204:207], v14, s[12:15], s95 offen offset:2304 sc1
    s_add_u32 s95, s95, 4096
    s_barrier
    buffer_load_dwordx4 v[208:211], v14, s[12:15], s95 offen offset:0 sc1
    buffer_load_dwordx4 v[212:215], v14, s[12:15], s95 offen offset:256 sc1
    buffer_load_dwordx4 v[216:219], v14, s[12:15], s95 offen offset:2048 sc1
    buffer_load_dwordx4 v[220:223], v14, s[12:15], s95 offen offset:2304 sc1
    s_add_u32 s95, s95, 4096
    buffer_load_dwordx4 v[224:227], v14, s[12:15], s95 offen offset:0 sc1
    buffer_load_dwordx4 v[228:231], v14, s[12:15], s95 offen offset:256 sc1
    buffer_load_dwordx4 v[232:235], v14, s[12:15], s95 offen offset:2048 sc1
    buffer_load_dwordx4 v[236:239], v14, s[12:15], s95 offen offset:2304 sc1
    s_add_u32 s95, s95, 4096
    buffer_load_dwordx4 v[240:243], v14, s[12:15], s95 offen offset:0 sc1
    buffer_load_dwordx4 v[244:247], v14, s[12:15], s95 offen offset:256 sc1
    buffer_load_dwordx4 v[248:251], v14, s[12:15], s95 offen offset:2048 sc1
    buffer_load_dwordx4 v[252:255], v14, s[12:15], s95 offen offset:2304 sc1
    s_add_u32 s95, s95, 4096
    buffer_load_dwordx4 v[32:35], v14, s[12:15], s95 offen offset:0 sc1
    buffer_load_dwordx4 v[36:39], v14, s[12:15], s95 offen offset:256 sc1
    s_waitcnt vmcnt(1)
    buffer_load_dwordx4 v[40:43], v14, s[12:15], s95 offen offset:2048 sc1
    s_waitcnt vmcnt(1)
    buffer_load_dwordx4 v[44:47], v14, s[12:15], s95 offen offset:2304 sc1
    s_add_u32 s95, s95, 4096
    s_waitcnt vmcnt(1)
    buffer_load_dwordx4 v[48:51], v14, s[12:15], s95 offen offset:0 sc1
    s_waitcnt vmcnt(1)
    buffer_load_dwordx4 v[52:55], v14, s[12:15], s95 offen offset:256 sc1
    s_waitcnt vmcnt(1)
    buffer_load_dwordx4 v[56:59], v14, s[12:15], s95 offen offset:2048 sc1
    s_waitcnt vmcnt(1)
    buffer_load_dwordx4 v[60:63], v14, s[12:15], s95 offen offset:2304 sc1
    s_add_u32 s95, s95, 4096
    s_waitcnt vmcnt(1)
    buffer_load_dwordx4 v[64:67], v14, s[12:15], s95 offen offset:0 sc1
    s_waitcnt vmcnt(1)
    buffer_load_dwordx4 v[68:71], v14, s[12:15], s95 offen offset:256 sc1
    s_lshl2_add_u32 s28, s4, s68
    s_lshl_b32 s28, s28, 8
    s_add_u32 s28, s28, 16384
    v_and_b32 v12, 31, v0
    v_min_u32 v12, 13, v12
    v_and_b32 v13, 32, v0
    v_add_lshl_u32 v12, v12, v13, 2
    s_cmp_lg_u32 s26, 0
    s_cbranch_scc1 Lpollg_25
Lpoll_24:
    buffer_load_dword v16, v12, s[12:15], s28 offen sc1
    s_sub_u32 s27, s27, 1
    s_waitcnt vmcnt(0)
    v_cmp_ne_u32 vcc, s25, v16
    s_cbranch_scc1 Lpollr_27
    s_cbranch_vccnz Lpoll_24
Lpolld_26:
    s_waitcnt lgkmcnt(0)
    s_barrier
    buffer_load_dwordx4 v[72:75], v14, s[12:15], s95 offen offset:2048 sc1
    buffer_load_dwordx4 v[76:79], v14, s[12:15], s95 offen offset:2304 sc1
    s_add_u32 s95, s95, 4096
    buffer_load_dwordx4 v[80:83], v14, s[12:15], s95 offen offset:0 sc1
    buffer_load_dwordx4 v[84:87], v14, s[12:15], s95 offen offset:256 sc1
    buffer_load_dwordx4 v[88:91], v14, s[12:15], s95 offen offset:2048 sc1
    buffer_load_dwordx4 v[92:95], v14, s[12:15], s95 offen offset:2304 sc1
    s_add_u32 s95, s95, 4096
    buffer_load_dwordx4 v[96:99], v14, s[12:15], s95 offen offset:0 sc1
    buffer_load_dwordx4 v[100:103], v14, s[12:15], s95 offen offset:256 sc1
    buffer_load_dwordx4 v[104:107], v14, s[12:15], s95 offen offset:2048 sc1
    buffer_load_dwordx4 v[108:111], v14, s[12:15], s95 offen offset:2304 sc1
    s_add_u32 s95, s95, 4096
    s_add_u32 m0, s79, 133120
    s_nop 0
    buffer_load_dwordx4 v1, s[12:15], s95 offen offset:0 sc1 lds
    buffer_load_dwordx4 v1, s[12:15], s95 offen offset:1024 sc1 lds
    buffer_load_dwordx4 v1, s[12:15], s95 offen offset:2048 sc1 lds
    buffer_load_dwordx4 v1, s[12:15], s95 offen offset:3072 sc1 lds
    s_and_b32 s29, s76, 7
    s_lshr_b32 s31, s68, 1
    s_lshl1_add_u32 s58, s76, s31
    s_lshl1_add_u32 s29, s29, s31
    s_mul_i32 s29, s29, 43008
    s_add_u32 s29, s29, s99
    s_and_b32 s30, s68, 1
    s_mul_i32 s58, s58, 7
    s_add_u32 s58, s58, s30
    s_lshl_b32 s58, s58, 11
    s_mul_i32 s59, s30, 14336
    s_mul_i32 s31, s30, 6144
    s_add_u32 s31, s31, s29
    s_mul_i32 s30, s30, 43008
    s_lshl1_add_u32 s29, s30, s29
    s_lshl_b32 s71, s68, 12
    s_lshr_b32 s28, s68, 1
    s_lshl_b32 s32, s28, 13
    v_add_u32 v2, s32, v14
    v_add_u32 v3, 65536, v2
    v_and_b32 v4, 15, v0
    v_min_u32 v6, 13, v4
    v_and_b32 v7, 48, v0
    v_lshlrev_b32 v7, 1, v7
    v_add_lshl_u32 v6, v6, v7, 2
    v_mov_b32 v0, v1
    s_mul_i32 s56, s28, 8704
    s_and_b32 s32, s68, 1
    s_lshl_b32 s33, s32, 12
    s_add_u32 s33, s33, 133120
    s_lshl_b32 s32, s32, 7
    s_add_u32 s56, s56, s32
    s_add_u32 s56, s56, 114688
    s_and_b32 s28, s76, 60
    s_lshl_b32 s28, s28, 7
    s_add_u32 s28, s28, 24576
    s_barrier
    s_cmp_lg_u32 s26, 0
    s_cbranch_scc1 Lpollg_30
Lpoll_29:
    buffer_load_dword v8, v6, s[12:15], s28 offen sc1
    s_sub_u32 s27, s27, 1
    s_waitcnt vmcnt(0)
    v_cmp_ne_u32 vcc, s25, v8
    s_cbranch_scc1 Lpollr_32
    s_cbranch_vccnz Lpoll_29
Lpolld_31:
    s_add_u32 m0, s71, 0
    s_add_u32 s34, s29, 0
    buffer_load_dwordx4 v0, s[12:15], s34 offen offset:0 sc1 lds
    buffer_load_dwordx4 v0, s[12:15], s34 offen offset:1024 sc1 lds
    buffer_load_dwordx4 v0, s[12:15], s34 offen offset:2048 sc1 lds
    buffer_load_dwordx4 v0, s[12:15], s34 offen offset:3072 sc1 lds
    s_add_u32 m0, s71, 16384
    s_add_u32 s34, s29, 6144
    buffer_load_dwordx4 v0, s[12:15], s34 offen offset:0 sc1 lds
    buffer_load_dwordx4 v0, s[12:15], s34 offen offset:1024 sc1 lds
    buffer_load_dwordx4 v0, s[12:15], s34 offen offset:2048 sc1 lds
    buffer_load_dwordx4 v0, s[12:15], s34 offen offset:3072 sc1 lds
    s_add_u32 m0, s71, 32768
    s_add_u32 s34, s29, 12288
    buffer_load_dwordx4 v0, s[12:15], s34 offen offset:0 sc1 lds
    buffer_load_dwordx4 v0, s[12:15], s34 offen offset:1024 sc1 lds
    buffer_load_dwordx4 v0, s[12:15], s34 offen offset:2048 sc1 lds
    buffer_load_dwordx4 v0, s[12:15], s34 offen offset:3072 sc1 lds
    s_setprio 3
    s_waitcnt vmcnt(8)
    s_barrier
    ds_read_b128 v[4:7], v2 offset:0
    ds_read_b128 v[8:11], v2 offset:256
    ds_read_b128 v[12:15], v2 offset:4096
    s_waitcnt lgkmcnt(2)
    v_mfma_f32_16x16x32_bf16 v[16:19], v[128:131], v[4:7], 0
    s_add_u32 m0, s71, 49152
    s_add_u32 s34, s29, 18432
    buffer_load_dwordx4 v0, s[12:15], s34 offen offset:0 sc1 lds
    v_mfma_f32_16x16x32_bf16 v[20:23], v[132:135], v[4:7], 0
    ds_read_b128 v[4:7], v2 offset:4352
    s_waitcnt lgkmcnt(2)
    v_mfma_f32_16x16x32_bf16 v[24:27], v[128:131], v[8:11], 0
    v_mfma_f32_16x16x32_bf16 v[28:31], v[132:135], v[8:11], 0
    ds_read_b128 v[8:11], v2 offset:2048
    s_waitcnt lgkmcnt(2)
    v_mfma_f32_16x16x32_bf16 v[112:115], v[128:131], v[12:15], 0
    buffer_load_dwordx4 v0, s[12:15], s34 offen offset:1024 sc1 lds
    v_mfma_f32_16x16x32_bf16 v[116:119], v[132:135], v[12:15], 0
    ds_read_b128 v[12:15], v2 offset:2304
    s_waitcnt lgkmcnt(2)
    v_mfma_f32_16x16x32_bf16 v[120:123], v[128:131], v[4:7], 0
    v_mfma_f32_16x16x32_bf16 v[124:127], v[132:135], v[4:7], 0
    ds_read_b128 v[4:7], v2 offset:6144
    s_waitcnt lgkmcnt(2)
    v_mfma_f32_16x16x32_bf16 v[16:19], v[136:139], v[8:11], v[16:19]
    buffer_load_dwordx4 v0, s[12:15], s34 offen offset:2048 sc1 lds
    v_mfma_f32_16x16x32_bf16 v[20:23], v[140:143], v[8:11], v[20:23]
    ds_read_b128 v[8:11], v2 offset:6400
    s_waitcnt lgkmcnt(2)
    v_mfma_f32_16x16x32_bf16 v[24:27], v[136:139], v[12:15], v[24:27]
    v_mfma_f32_16x16x32_bf16 v[28:31], v[140:143], v[12:15], v[28:31]
    s_waitcnt vmcnt(7)
    s_barrier
    ds_read_b128 v[12:15], v2 offset:16384
    s_waitcnt lgkmcnt(2)
    v_mfma_f32_16x16x32_bf16 v[112:115], v[136:139], v[4:7], v[112:115]
    buffer_load_dwordx4 v0, s[12:15], s34 offen offset:3072 sc1 lds
    v_mfma_f32_16x16x32_bf16 v[116:119], v[140:143], v[4:7], v[116:119]
    ds_read_b128 v[4:7], v2 offset:16640
    s_waitcnt lgkmcnt(2)
    v_mfma_f32_16x16x32_bf16 v[120:123], v[136:139], v[8:11], v[120:123]
    v_mfma_f32_16x16x32_bf16 v[124:127], v[140:143], v[8:11], v[124:127]
    ds_read_b128 v[8:11], v2 offset:20480
    s_waitcnt lgkmcnt(2)
    v_mfma_f32_16x16x32_bf16 v[16:19], v[160:163], v[12:15], v[16:19]
    s_add_u32 m0, s71, 65536
    s_add_u32 s34, s29, 24576
    buffer_load_dwordx4 v0, s[12:15], s34 offen offset:0 sc1 lds
    v_mfma_f32_16x16x32_bf16 v[20:23], v[164:167], v[12:15], v[20:23]
    ds_read_b128 v[12:15], v2 offset:20736
    s_waitcnt lgkmcnt(2)
    v_mfma_f32_16x16x32_bf16 v[24:27], v[160:163], v[4:7], v[24:27]
    v_mfma_f32_16x16x32_bf16 v[28:31], v[164:167], v[4:7], v[28:31]
    ds_read_b128 v[4:7], v2 offset:18432
    s_waitcnt lgkmcnt(2)
    v_mfma_f32_16x16x32_bf16 v[112:115], v[160:163], v[8:11], v[112:115]
    buffer_load_dwordx4 v0, s[12:15], s34 offen offset:1024 sc1 lds
    v_mfma_f32_16x16x32_bf16 v[116:119], v[164:167], v[8:11], v[116:119]
    ds_read_b128 v[8:11], v2 offset:18688
    s_waitcnt lgkmcnt(2)
    v_mfma_f32_16x16x32_bf16 v[120:123], v[160:163], v[12:15], v[120:123]
    v_mfma_f32_16x16x32_bf16 v[124:127], v[164:167], v[12:15], v[124:127]
    ds_read_b128 v[12:15], v2 offset:22528
    ds_read_b128 v[164:167], v2 offset:22784
    s_waitcnt lgkmcnt(3)
    v_mfma_f32_16x16x32_bf16 v[16:19], v[168:171], v[4:7], v[16:19]
    buffer_load_dwordx4 v0, s[12:15], s34 offen offset:2048 sc1 lds
    v_mfma_f32_16x16x32_bf16 v[20:23], v[172:175], v[4:7], v[20:23]
    s_waitcnt vmcnt(7)
    s_barrier
    ds_read_b128 v[4:7], v2 offset:32768
    s_waitcnt lgkmcnt(3)
    v_mfma_f32_16x16x32_bf16 v[24:27], v[168:171], v[8:11], v[24:27]
    buffer_load_dwordx4 v0, s[12:15], s34 offen offset:3072 sc1 lds
    v_mfma_f32_16x16x32_bf16 v[28:31], v[172:175], v[8:11], v[28:31]
    ds_read_b128 v[8:11], v2 offset:33024
    s_waitcnt lgkmcnt(3)
    v_mfma_f32_16x16x32_bf16 v[112:115], v[168:171], v[12:15], v[112:115]
    s_add_u32 m0, s71, 81920
    s_add_u32 s34, s29, 30720
    buffer_load_dwordx4 v0, s[12:15], s34 offen offset:0 sc1 lds
    v_mfma_f32_16x16x32_bf16 v[116:119], v[172:175], v[12:15], v[116:119]
    ds_read_b128 v[12:15], v2 offset:36864
    s_waitcnt lgkmcnt(3)
    v_mfma_f32_16x16x32_bf16 v[120:123], v[168:171], v[164:167], v[120:123]
    v_mfma_f32_16x16x32_bf16 v[124:127], v[172:175], v[164:167], v[124:127]
    ds_read_b128 v[164:167], v2 offset:37120
    ds_read_b128 v[168:171], v2 offset:34816
    s_waitcnt lgkmcnt(4)
    v_mfma_f32_16x16x32_bf16 v[16:19], v[192:195], v[4:7], v[16:19]
    buffer_load_dwordx4 v0, s[12:15], s34 offen offset:1024 sc1 lds
    v_mfma_f32_16x16x32_bf16 v[20:23], v[196:199], v[4:7], v[20:23]
    ds_read_b128 v[172:175], v2 offset:35072
    ds_read_b128 v[4:7], v2 offset:38912
    s_waitcnt lgkmcnt(5)
    v_mfma_f32_16x16x32_bf16 v[24:27], v[192:195], v[8:11], v[24:27]
    v_mfma_f32_16x16x32_bf16 v[28:31], v[196:199], v[8:11], v[28:31]
    v_add_u32 v160, s33, v2
    ds_read_b128 v[8:11], v2 offset:39168
    s_waitcnt lgkmcnt(5)
    v_mfma_f32_16x16x32_bf16 v[112:115], v[192:195], v[12:15], v[112:115]
    buffer_load_dwordx4 v0, s[12:15], s34 offen offset:2048 sc1 lds
    v_mfma_f32_16x16x32_bf16 v[116:119], v[196:199], v[12:15], v[116:119]
    s_waitcnt vmcnt(7)
    s_barrier
    ds_read_b128 v[12:15], v2 offset:49152
    s_waitcnt lgkmcnt(5)
    v_mfma_f32_16x16x32_bf16 v[120:123], v[192:195], v[164:167], v[120:123]
    buffer_load_dwordx4 v0, s[12:15], s34 offen offset:3072 sc1 lds
    v_mfma_f32_16x16x32_bf16 v[124:127], v[196:199], v[164:167], v[124:127]
    ds_read_b128 v[164:167], v2 offset:49408
    ds_read_b128 v[192:195], v2 offset:53248
    s_waitcnt lgkmcnt(6)
    v_mfma_f32_16x16x32_bf16 v[16:19], v[200:203], v[168:171], v[16:19]
    s_add_u32 m0, s71, 98304
    s_add_u32 s34, s29, 36864
    buffer_load_dwordx4 v0, s[12:15], s34 offen offset:0 sc1 lds
    v_mfma_f32_16x16x32_bf16 v[20:23], v[204:207], v[168:171], v[20:23]
    ds_read_b128 v[196:199], v2 offset:53504
    ds_read_b128 v[168:171], v2 offset:51200
    s_waitcnt lgkmcnt(7)
    v_mfma_f32_16x16x32_bf16 v[24:27], v[200:203], v[172:175], v[24:27]
    v_mfma_f32_16x16x32_bf16 v[28:31], v[204:207], v[172:175], v[28:31]
    ds_read_b128 v[128:131], v160 offset:0
    ds_read_b128 v[172:175], v2 offset:51456
    s_waitcnt lgkmcnt(8)
    v_mfma_f32_16x16x32_bf16 v[112:115], v[200:203], v[4:7], v[112:115]
    buffer_load_dwordx4 v0, s[12:15], s34 offen offset:1024 sc1 lds
    v_mfma_f32_16x16x32_bf16 v[116:119], v[204:207], v[4:7], v[116:119]
    ds_read_b128 v[4:7], v2 offset:55296
    s_waitcnt lgkmcnt(8)
    v_mfma_f32_16x16x32_bf16 v[120:123], v[200:203], v[8:11], v[120:123]
    v_mfma_f32_16x16x32_bf16 v[124:127], v[204:207], v[8:11], v[124:127]
    ds_read_b128 v[132:135], v160 offset:256
    ds_read_b128 v[8:11], v2 offset:55552
    s_waitcnt lgkmcnt(9)
    v_mfma_f32_16x16x32_bf16 v[16:19], v[224:227], v[12:15], v[16:19]
    buffer_load_dwordx4 v0, s[12:15], s34 offen offset:2048 sc1 lds
    v_mfma_f32_16x16x32_bf16 v[20:23], v[228:231], v[12:15], v[20:23]
    s_waitcnt vmcnt(7)
    s_barrier
    ds_read_b128 v[12:15], v3 offset:0
    s_waitcnt lgkmcnt(9)
    v_mfma_f32_16x16x32_bf16 v[24:27], v[224:227], v[164:167], v[24:27]
    buffer_load_dwordx4 v0, s[12:15], s34 offen offset:3072 sc1 lds
    v_mfma_f32_16x16x32_bf16 v[28:31], v[228:231], v[164:167], v[28:31]
    ds_read_b128 v[136:139], v160 offset:2048
    ds_read_b128 v[164:167], v3 offset:256
    s_waitcnt lgkmcnt(10)
    v_mfma_f32_16x16x32_bf16 v[112:115], v[224:227], v[192:195], v[112:115]
    v_mfma_f32_16x16x32_bf16 v[116:119], v[228:231], v[192:195], v[116:119]
    ds_read_b128 v[192:195], v3 offset:4096
    s_waitcnt lgkmcnt(10)
    v_mfma_f32_16x16x32_bf16 v[120:123], v[224:227], v[196:199], v[120:123]
    v_mfma_f32_16x16x32_bf16 v[124:127], v[228:231], v[196:199], v[124:127]
    ds_read_b128 v[140:143], v160 offset:2304
    ds_read_b128 v[196:199], v3 offset:4352
    s_waitcnt lgkmcnt(11)
    v_mfma_f32_16x16x32_bf16 v[16:19], v[232:235], v[168:171], v[16:19]
    v_mfma_f32_16x16x32_bf16 v[20:23], v[236:239], v[168:171], v[20:23]
    ds_read_b128 v[168:171], v3 offset:2048
    s_waitcnt lgkmcnt(10)
    v_mfma_f32_16x16x32_bf16 v[24:27], v[232:235], v[172:175], v[24:27]
    v_mfma_f32_16x16x32_bf16 v[28:31], v[236:239], v[172:175], v[28:31]
    ds_read_b128 v[172:175], v3 offset:2304
    s_waitcnt lgkmcnt(10)
    v_mfma_f32_16x16x32_bf16 v[112:115], v[232:235], v[4:7], v[112:115]
    v_mfma_f32_16x16x32_bf16 v[116:119], v[236:239], v[4:7], v[116:119]
    v_bfe_u32 v161, v0, 4, 4
    ds_read_b128 v[4:7], v3 offset:6144
    s_waitcnt lgkmcnt(9)
    v_mfma_f32_16x16x32_bf16 v[120:123], v[232:235], v[8:11], v[120:123]
    v_mfma_f32_16x16x32_bf16 v[124:127], v[236:239], v[8:11], v[124:127]
    v_mul_u32_u24 v161, 272, v161
    ds_read_b128 v[8:11], v3 offset:6400
    s_waitcnt lgkmcnt(9)
    v_mfma_f32_16x16x32_bf16 v[16:19], v[32:35], v[12:15], v[16:19]
    v_mfma_f32_16x16x32_bf16 v[20:23], v[36:39], v[12:15], v[20:23]
    v_lshrrev_b32 v162, 8, v0
    s_waitcnt vmcnt(4)
    s_barrier
    ds_read_b128 v[12:15], v3 offset:16384
    s_waitcnt lgkmcnt(8)
    v_mfma_f32_16x16x32_bf16 v[24:27], v[32:35], v[164:167], v[24:27]
    s_add_u32 m0, s71, 0
    s_add_u32 s34, s31, 4096
    buffer_load_dwordx4 v0, s[12:15], s34 offen offset:0 sc1 lds
    v_mfma_f32_16x16x32_bf16 v[28:31], v[36:39], v[164:167], v[28:31]
    v_lshl_add_u32 v161, v162, 4, v161
    ds_read_b128 v[164:167], v3 offset:16640
    s_waitcnt lgkmcnt(8)
    v_mfma_f32_16x16x32_bf16 v[112:115], v[32:35], v[192:195], v[112:115]
    buffer_load_dwordx4 v0, s[12:15], s34 offen offset:1024 sc1 lds
    v_mfma_f32_16x16x32_bf16 v[116:119], v[36:39], v[192:195], v[116:119]
    v_add_u32 v161, s56, v161
    ds_read_b128 v[192:195], v3 offset:20480
    s_waitcnt lgkmcnt(7)
    v_mfma_f32_16x16x32_bf16 v[120:123], v[32:35], v[196:199], v[120:123]
    s_add_u32 s34, s58, 3667968
    buffer_load_dwordx4 v0, s[12:15], s34 offen offset:2048 sc1 lds
    v_mfma_f32_16x16x32_bf16 v[124:127], v[36:39], v[196:199], v[124:127]
    ds_read_b128 v[196:199], v3 offset:20736
    s_waitcnt lgkmcnt(7)
    v_mfma_f32_16x16x32_bf16 v[16:19], v[40:43], v[168:171], v[16:19]
    buffer_load_dwordx4 v0, s[12:15], s34 offen offset:3072 sc1 lds
    v_mfma_f32_16x16x32_bf16 v[20:23], v[44:47], v[168:171], v[20:23]
    ds_read_b128 v[168:171], v3 offset:18432
    s_waitcnt lgkmcnt(7)
    v_mfma_f32_16x16x32_bf16 v[24:27], v[40:43], v[172:175], v[24:27]
    v_mfma_f32_16x16x32_bf16 v[28:31], v[44:47], v[172:175], v[28:31]
    ds_read_b128 v[172:175], v3 offset:18688
    s_waitcnt lgkmcnt(7)
    v_mfma_f32_16x16x32_bf16 v[112:115], v[40:43], v[4:7], v[112:115]
    s_add_u32 m0, s71, 16384
    s_add_u32 s34, s31, 16384
    buffer_load_dwordx4 v0, s[12:15], s34 offen offset:0 sc1 lds
    v_mfma_f32_16x16x32_bf16 v[116:119], v[44:47], v[4:7], v[116:119]
    ds_read_b128 v[4:7], v3 offset:22528
    s_waitcnt lgkmcnt(7)
    v_mfma_f32_16x16x32_bf16 v[120:123], v[40:43], v[8:11], v[120:123]
    v_mfma_f32_16x16x32_bf16 v[124:127], v[44:47], v[8:11], v[124:127]
    ds_read_b128 v[8:11], v3 offset:22784
    s_waitcnt lgkmcnt(7)
    v_mfma_f32_16x16x32_bf16 v[16:19], v[64:67], v[12:15], v[16:19]
    buffer_load_dwordx4 v0, s[12:15], s34 offen offset:1024 sc1 lds
    v_mfma_f32_16x16x32_bf16 v[20:23], v[68:71], v[12:15], v[20:23]
    s_waitcnt vmcnt(6)
    s_barrier
    ds_read_b128 v[12:15], v3 offset:32768
    s_waitcnt lgkmcnt(7)
    v_mfma_f32_16x16x32_bf16 v[24:27], v[64:67], v[164:167], v[24:27]
    s_add_u32 s34, s58, 3672064
    buffer_load_dwordx4 v0, s[12:15], s34 offen offset:2048 sc1 lds
    v_mfma_f32_16x16x32_bf16 v[28:31], v[68:71], v[164:167], v[28:31]
    ds_read_b128 v[164:167], v3 offset:33024
    s_waitcnt lgkmcnt(7)
    v_mfma_f32_16x16x32_bf16 v[112:115], v[64:67], v[192:195], v[112:115]
    buffer_load_dwordx4 v0, s[12:15], s34 offen offset:3072 sc1 lds
    v_mfma_f32_16x16x32_bf16 v[116:119], v[68:71], v[192:195], v[116:119]
    ds_read_b128 v[192:195], v3 offset:36864
    s_waitcnt lgkmcnt(7)
    v_mfma_f32_16x16x32_bf16 v[120:123], v[64:67], v[196:199], v[120:123]
    v_mfma_f32_16x16x32_bf16 v[124:127], v[68:71], v[196:199], v[124:127]
    ds_read_b128 v[196:199], v3 offset:37120
    s_waitcnt lgkmcnt(7)
    v_mfma_f32_16x16x32_bf16 v[16:19], v[72:75], v[168:171], v[16:19]
    s_add_u32 m0, s71, 32768
    s_add_u32 s34, s31, 28672
    buffer_load_dwordx4 v0, s[12:15], s34 offen offset:0 sc1 lds
    v_mfma_f32_16x16x32_bf16 v[20:23], v[76:79], v[168:171], v[20:23]
    ds_read_b128 v[168:171], v3 offset:34816
    s_waitcnt lgkmcnt(7)
    v_mfma_f32_16x16x32_bf16 v[24:27], v[72:75], v[172:175], v[24:27]
    v_mfma_f32_16x16x32_bf16 v[28:31], v[76:79], v[172:175], v[28:31]
    ds_read_b128 v[172:175], v3 offset:35072
    s_waitcnt lgkmcnt(7)
    v_mfma_f32_16x16x32_bf16 v[112:115], v[72:75], v[4:7], v[112:115]
    buffer_load_dwordx4 v0, s[12:15], s34 offen offset:1024 sc1 lds
    v_mfma_f32_16x16x32_bf16 v[116:119], v[76:79], v[4:7], v[116:119]
    ds_read_b128 v[4:7], v3 offset:38912
    s_waitcnt lgkmcnt(7)
    v_mfma_f32_16x16x32_bf16 v[120:123], v[72:75], v[8:11], v[120:123]
    v_mfma_f32_16x16x32_bf16 v[124:127], v[76:79], v[8:11], v[124:127]
    ds_read_b128 v[8:11], v3 offset:39168
    s_waitcnt lgkmcnt(7)
    v_mfma_f32_16x16x32_bf16 v[16:19], v[96:99], v[12:15], v[16:19]
    s_add_u32 s34, s58, 3676160
    buffer_load_dwordx4 v0, s[12:15], s34 offen offset:2048 sc1 lds
    v_mfma_f32_16x16x32_bf16 v[20:23], v[100:103], v[12:15], v[20:23]
    s_waitcnt vmcnt(7)
    s_barrier
    ds_read_b128 v[12:15], v2 offset:0
    s_waitcnt lgkmcnt(7)
    v_mfma_f32_16x16x32_bf16 v[24:27], v[96:99], v[164:167], v[24:27]
    buffer_load_dwordx4 v0, s[12:15], s34 offen offset:3072 sc1 lds
    v_mfma_f32_16x16x32_bf16 v[28:31], v[100:103], v[164:167], v[28:31]
    ds_read_b128 v[164:167], v2 offset:256
    s_waitcnt lgkmcnt(7)
    v_mfma_f32_16x16x32_bf16 v[112:115], v[96:99], v[192:195], v[112:115]
    s_add_u32 m0, s71, 49152
    s_add_u32 s34, s31, 40960
    s_add_u32 s34, s34, s30
    buffer_load_dwordx4 v0, s[12:15], s34 offen offset:0 sc1 lds
    v_mfma_f32_16x16x32_bf16 v[116:119], v[100:103], v[192:195], v[116:119]
    ds_read_b128 v[192:195], v2 offset:2048
    s_waitcnt lgkmcnt(7)
    v_mfma_f32_16x16x32_bf16 v[120:123], v[96:99], v[196:199], v[120:123]
    v_mfma_f32_16x16x32_bf16 v[124:127], v[100:103], v[196:199], v[124:127]
    ds_read_b128 v[196:199], v2 offset:2304
    s_waitcnt lgkmcnt(7)
    v_mfma_f32_16x16x32_bf16 v[16:19], v[104:107], v[168:171], v[16:19]
    buffer_load_dwordx4 v0, s[12:15], s34 offen offset:1024 sc1 lds
    v_mfma_f32_16x16x32_bf16 v[20:23], v[108:111], v[168:171], v[20:23]
    ds_read_b128 v[168:171], v2 offset:4096
    s_waitcnt lgkmcnt(7)
    v_mfma_f32_16x16x32_bf16 v[24:27], v[104:107], v[172:175], v[24:27]
    v_mfma_f32_16x16x32_bf16 v[28:31], v[108:111], v[172:175], v[28:31]
    ds_read_b128 v[172:175], v2 offset:4352
    s_waitcnt lgkmcnt(7)
    v_mfma_f32_16x16x32_bf16 v[112:115], v[104:107], v[4:7], v[112:115]
    s_add_u32 s34, s58, 3680256
    s_add_u32 s34, s34, s59
    buffer_load_dwordx4 v0, s[12:15], s34 offen offset:2048 sc1 lds
    v_mfma_f32_16x16x32_bf16 v[116:119], v[108:111], v[4:7], v[116:119]
    ds_read_b128 v[4:7], v2 offset:6144
    s_waitcnt lgkmcnt(7)
    v_mfma_f32_16x16x32_bf16 v[120:123], v[104:107], v[8:11], v[120:123]
    v_mfma_f32_16x16x32_bf16 v[124:127], v[108:111], v[8:11], v[124:127]
    ds_read_b128 v[8:11], v2 offset:6400
    s_waitcnt lgkmcnt(7)
    v_mfma_f32_16x16x32_bf16 v[16:19], v[144:147], v[12:15], v[16:19]
    buffer_load_dwordx4 v0, s[12:15], s34 offen offset:3072 sc1 lds
    v_mfma_f32_16x16x32_bf16 v[20:23], v[148:151], v[12:15], v[20:23]
    s_waitcnt vmcnt(8)
    s_barrier
    ds_read_b128 v[12:15], v2 offset:16384
    s_waitcnt lgkmcnt(7)
    v_mfma_f32_16x16x32_bf16 v[24:27], v[144:147], v[164:167], v[24:27]
    v_mfma_f32_16x16x32_bf16 v[28:31], v[148:151], v[164:167], v[28:31]
    ds_read_b128 v[164:167], v2 offset:16640
    s_waitcnt lgkmcnt(7)
    v_mfma_f32_16x16x32_bf16 v[16:19], v[152:155], v[192:195], v[16:19]
    s_add_u32 m0, s71, 65536
    s_add_u32 s34, s31, 96256
    buffer_load_dwordx4 v0, s[12:15], s34 offen offset:0 sc1 lds
    v_mfma_f32_16x16x32_bf16 v[20:23], v[156:159], v[192:195], v[20:23]
    ds_read_b128 v[192:195], v2 offset:18432
    s_waitcnt lgkmcnt(7)
    v_mfma_f32_16x16x32_bf16 v[24:27], v[152:155], v[196:199], v[24:27]
    v_mfma_f32_16x16x32_bf16 v[28:31], v[156:159], v[196:199], v[28:31]
    ds_read_b128 v[196:199], v2 offset:18688
    s_waitcnt lgkmcnt(7)
    v_mfma_f32_16x16x32_bf16 v[16:19], v[176:179], v[168:171], v[16:19]
    buffer_load_dwordx4 v0, s[12:15], s34 offen offset:1024 sc1 lds
    v_mfma_f32_16x16x32_bf16 v[20:23], v[180:183], v[168:171], v[20:23]
    ds_read_b128 v[168:171], v2 offset:20480
    s_waitcnt lgkmcnt(7)
    v_mfma_f32_16x16x32_bf16 v[24:27], v[176:179], v[172:175], v[24:27]
    v_mfma_f32_16x16x32_bf16 v[28:31], v[180:183], v[172:175], v[28:31]
    ds_read_b128 v[172:175], v2 offset:20736
    s_waitcnt lgkmcnt(7)
    v_mfma_f32_16x16x32_bf16 v[16:19], v[184:187], v[4:7], v[16:19]
    s_add_u32 s34, s58, 3698688
    buffer_load_dwordx4 v0, s[12:15], s34 offen offset:2048 sc1 lds
    v_mfma_f32_16x16x32_bf16 v[20:23], v[188:191], v[4:7], v[20:23]
    ds_read_b128 v[4:7], v2 offset:22528
    s_waitcnt lgkmcnt(7)
    v_mfma_f32_16x16x32_bf16 v[24:27], v[184:187], v[8:11], v[24:27]
    v_mfma_f32_16x16x32_bf16 v[28:31], v[188:191], v[8:11], v[28:31]
    ds_read_b128 v[8:11], v2 offset:22784
    s_waitcnt lgkmcnt(7)
    v_mfma_f32_16x16x32_bf16 v[16:19], v[208:211], v[12:15], v[16:19]
    buffer_load_dwordx4 v0, s[12:15], s34 offen offset:3072 sc1 lds
    v_mfma_f32_16x16x32_bf16 v[20:23], v[212:215], v[12:15], v[20:23]
    s_waitcnt vmcnt(8)
    s_barrier
LB_tail:
    ds_read_b128 v[12:15], v2 offset:32768
    s_waitcnt lgkmcnt(7)
    v_mfma_f32_16x16x32_bf16 v[24:27], v[208:211], v[164:167], v[24:27]
    v_mfma_f32_16x16x32_bf16 v[28:31], v[212:215], v[164:167], v[28:31]
    ds_read_b128 v[164:167], v2 offset:33024
    s_waitcnt lgkmcnt(7)
    v_mfma_f32_16x16x32_bf16 v[16:19], v[216:219], v[192:195], v[16:19]
    s_add_u32 m0, s71, 81920
    s_add_u32 s34, s31, 108544
    buffer_load_dwordx4 v0, s[12:15], s34 offen offset:0 sc1 lds
    v_mfma_f32_16x16x32_bf16 v[20:23], v[220:223], v[192:195], v[20:23]
    ds_read_b128 v[192:195], v2 offset:34816
    s_waitcnt lgkmcnt(7)
    v_mfma_f32_16x16x32_bf16 v[24:27], v[216:219], v[196:199], v[24:27]
    v_mfma_f32_16x16x32_bf16 v[28:31], v[220:223], v[196:199], v[28:31]
    ds_read_b128 v[196:199], v2 offset:35072
    s_waitcnt lgkmcnt(7)
    v_mfma_f32_16x16x32_bf16 v[16:19], v[240:243], v[168:171], v[16:19]
    buffer_load_dwordx4 v0, s[12:15], s34 offen offset:1024 sc1 lds
    v_mfma_f32_16x16x32_bf16 v[20:23], v[244:247], v[168:171], v[20:23]
    ds_read_b128 v[168:171], v2 offset:36864
    s_waitcnt lgkmcnt(7)
    v_mfma_f32_16x16x32_bf16 v[24:27], v[240:243], v[172:175], v[24:27]
    v_mfma_f32_16x16x32_bf16 v[28:31], v[244:247], v[172:175], v[28:31]
    ds_read_b128 v[172:175], v2 offset:37120
    s_waitcnt lgkmcnt(7)
    v_mfma_f32_16x16x32_bf16 v[16:19], v[248:251], v[4:7], v[16:19]
    s_add_u32 s34, s58, 3702784
    buffer_load_dwordx4 v0, s[12:15], s34 offen offset:2048 sc1 lds
    v_mfma_f32_16x16x32_bf16 v[20:23], v[252:255], v[4:7], v[20:23]
    ds_read_b128 v[4:7], v2 offset:38912
    s_waitcnt lgkmcnt(7)
    v_mfma_f32_16x16x32_bf16 v[24:27], v[248:251], v[8:11], v[24:27]
    v_mfma_f32_16x16x32_bf16 v[28:31], v[252:255], v[8:11], v[28:31]
    ds_read_b128 v[8:11], v2 offset:39168
    s_waitcnt lgkmcnt(7)
    v_mfma_f32_16x16x32_bf16 v[16:19], v[48:51], v[12:15], v[16:19]
    buffer_load_dwordx4 v0, s[12:15], s34 offen offset:3072 sc1 lds
    v_mfma_f32_16x16x32_bf16 v[20:23], v[52:55], v[12:15], v[20:23]
    s_waitcnt vmcnt(8)
    s_barrier
    ds_read_b128 v[12:15], v2 offset:49152
    s_waitcnt lgkmcnt(7)
    v_mfma_f32_16x16x32_bf16 v[24:27], v[48:51], v[164:167], v[24:27]
    v_mfma_f32_16x16x32_bf16 v[28:31], v[52:55], v[164:167], v[28:31]
    ds_read_b128 v[164:167], v2 offset:49408
    s_waitcnt lgkmcnt(7)
    v_mfma_f32_16x16x32_bf16 v[16:19], v[56:59], v[192:195], v[16:19]
    s_add_u32 m0, s71, 98304
    s_add_u32 s34, s31, 120832
    buffer_load_dwordx4 v0, s[12:15], s34 offen offset:0 sc1 lds
    v_mfma_f32_16x16x32_bf16 v[20:23], v[60:63], v[192:195], v[20:23]
    ds_read_b128 v[192:195], v2 offset:51200
    s_waitcnt lgkmcnt(7)
    v_mfma_f32_16x16x32_bf16 v[24:27], v[56:59], v[196:199], v[24:27]
    v_mfma_f32_16x16x32_bf16 v[28:31], v[60:63], v[196:199], v[28:31]
    ds_read_b128 v[196:199], v2 offset:51456
    s_waitcnt lgkmcnt(7)
    v_mfma_f32_16x16x32_bf16 v[16:19], v[80:83], v[168:171], v[16:19]
    buffer_load_dwordx4 v0, s[12:15], s34 offen offset:1024 sc1 lds
    v_mfma_f32_16x16x32_bf16 v[20:23], v[84:87], v[168:171], v[20:23]
    ds_read_b128 v[168:171], v2 offset:53248
    s_waitcnt lgkmcnt(7)
    v_mfma_f32_16x16x32_bf16 v[24:27], v[80:83], v[172:175], v[24:27]
    v_mfma_f32_16x16x32_bf16 v[28:31], v[84:87], v[172:175], v[28:31]
    ds_read_b128 v[172:175], v2 offset:53504
    s_waitcnt lgkmcnt(7)
    v_mfma_f32_16x16x32_bf16 v[16:19], v[88:91], v[4:7], v[16:19]
    s_add_u32 s34, s58, 3706880
    buffer_load_dwordx4 v0, s[12:15], s34 offen offset:2048 sc1 lds
    v_mfma_f32_16x16x32_bf16 v[20:23], v[92:95], v[4:7], v[20:23]
    ds_read_b128 v[4:7], v2 offset:55296
    s_waitcnt lgkmcnt(7)
    v_mfma_f32_16x16x32_bf16 v[24:27], v[88:91], v[8:11], v[24:27]
    v_mfma_f32_16x16x32_bf16 v[28:31], v[92:95], v[8:11], v[28:31]
    ds_read_b128 v[8:11], v2 offset:55552
    s_waitcnt lgkmcnt(7)
    v_mfma_f32_16x16x32_bf16 v[16:19], v[128:131], v[12:15], v[16:19]
    buffer_load_dwordx4 v0, s[12:15], s34 offen offset:3072 sc1 lds
    v_mfma_f32_16x16x32_bf16 v[20:23], v[132:135], v[12:15], v[20:23]
    s_waitcnt vmcnt(8)
    s_barrier
    ds_read_b128 v[12:15], v3 offset:0
    s_waitcnt lgkmcnt(7)
    v_mfma_f32_16x16x32_bf16 v[24:27], v[128:131], v[164:167], v[24:27]
    v_mfma_f32_16x16x32_bf16 v[28:31], v[132:135], v[164:167], v[28:31]
    ds_read_b128 v[164:167], v3 offset:256
    s_waitcnt lgkmcnt(7)
    v_mfma_f32_16x16x32_bf16 v[16:19], v[136:139], v[192:195], v[16:19]
    v_mfma_f32_16x16x32_bf16 v[20:23], v[140:143], v[192:195], v[20:23]
    ds_read_b128 v[192:195], v3 offset:2048
    s_waitcnt lgkmcnt(7)
    v_mfma_f32_16x16x32_bf16 v[24:27], v[136:139], v[196:199], v[24:27]
    v_mfma_f32_16x16x32_bf16 v[28:31], v[140:143], v[196:199], v[28:31]
    ds_read_b128 v[196:199], v3 offset:2304
    s_waitcnt lgkmcnt(7)
    v_mfma_f32_16x16x32_bf16 v[112:115], v[144:147], v[168:171], v[112:115]
    v_mfma_f32_16x16x32_bf16 v[116:119], v[148:151], v[168:171], v[116:119]
    ds_read_b128 v[168:171], v3 offset:4096
    s_waitcnt lgkmcnt(7)
    v_mfma_f32_16x16x32_bf16 v[120:123], v[144:147], v[172:175], v[120:123]
    v_mfma_f32_16x16x32_bf16 v[124:127], v[148:151], v[172:175], v[124:127]
    ds_read_b128 v[172:175], v3 offset:4352
    s_waitcnt lgkmcnt(7)
    v_mfma_f32_16x16x32_bf16 v[112:115], v[152:155], v[4:7], v[112:115]
    v_mfma_f32_16x16x32_bf16 v[116:119], v[156:159], v[4:7], v[116:119]
    ds_write_b128 v161, v[16:19] offset:0
    ds_read_b128 v[4:7], v3 offset:6144
    s_waitcnt lgkmcnt(8)
    v_mfma_f32_16x16x32_bf16 v[120:123], v[152:155], v[8:11], v[120:123]
    v_mfma_f32_16x16x32_bf16 v[124:127], v[156:159], v[8:11], v[124:127]
    ds_read_b128 v[8:11], v3 offset:6400
    s_waitcnt lgkmcnt(8)
    v_mfma_f32_16x16x32_bf16 v[112:115], v[176:179], v[12:15], v[112:115]
    v_mfma_f32_16x16x32_bf16 v[116:119], v[180:183], v[12:15], v[116:119]
    s_waitcnt vmcnt(4)
    s_barrier
    ds_read_b128 v[12:15], v3 offset:16384
    s_waitcnt lgkmcnt(8)
    v_mfma_f32_16x16x32_bf16 v[120:123], v[176:179], v[164:167], v[120:123]
    v_mfma_f32_16x16x32_bf16 v[124:127], v[180:183], v[164:167], v[124:127]
    ds_write_b128 v161, v[20:23] offset:64
    ds_read_b128 v[164:167], v3 offset:16640
    s_waitcnt lgkmcnt(9)
    v_mfma_f32_16x16x32_bf16 v[112:115], v[184:187], v[192:195], v[112:115]
    v_mfma_f32_16x16x32_bf16 v[116:119], v[188:191], v[192:195], v[116:119]
    ds_read_b128 v[192:195], v3 offset:18432
    s_waitcnt lgkmcnt(9)
    v_mfma_f32_16x16x32_bf16 v[120:123], v[184:187], v[196:199], v[120:123]
    v_mfma_f32_16x16x32_bf16 v[124:127], v[188:191], v[196:199], v[124:127]
    ds_read_b128 v[196:199], v3 offset:18688
    s_waitcnt lgkmcnt(9)
    v_mfma_f32_16x16x32_bf16 v[112:115], v[208:211], v[168:171], v[112:115]
    v_mfma_f32_16x16x32_bf16 v[116:119], v[212:215], v[168:171], v[116:119]
    ds_write_b128 v161, v[24:27] offset:4352
    ds_read_b128 v[168:171], v3 offset:20480
    s_waitcnt lgkmcnt(10)
    v_mfma_f32_16x16x32_bf16 v[120:123], v[208:211], v[172:175], v[120:123]
    v_mfma_f32_16x16x32_bf16 v[124:127], v[212:215], v[172:175], v[124:127]
    ds_read_b128 v[172:175], v3 offset:20736
    s_waitcnt lgkmcnt(9)
    v_mfma_f32_16x16x32_bf16 v[112:115], v[216:219], v[4:7], v[112:115]
    v_mfma_f32_16x16x32_bf16 v[116:119], v[220:223], v[4:7], v[116:119]
    ds_read_b128 v[4:7], v3 offset:22528
    s_waitcnt lgkmcnt(9)
    v_mfma_f32_16x16x32_bf16 v[120:123], v[216:219], v[8:11], v[120:123]
    v_mfma_f32_16x16x32_bf16 v[124:127], v[220:223], v[8:11], v[124:127]
    ds_write_b128 v161, v[28:31] offset:4416
    ds_read_b128 v[8:11], v3 offset:22784
    s_waitcnt lgkmcnt(10)
    v_mfma_f32_16x16x32_bf16 v[112:115], v[240:243], v[12:15], v[112:115]
    v_mfma_f32_16x16x32_bf16 v[116:119], v[244:247], v[12:15], v[116:119]
    s_waitcnt vmcnt(0) lgkmcnt(1)
    s_barrier
    ds_read_b128 v[12:15], v3 offset:32768
    v_mfma_f32_16x16x32_bf16 v[120:123], v[240:243], v[164:167], v[120:123]
    v_mfma_f32_16x16x32_bf16 v[124:127], v[244:247], v[164:167], v[124:127]
    ds_read_b128 v[164:167], v3 offset:33024
    v_mfma_f32_16x16x32_bf16 v[112:115], v[248:251], v[192:195], v[112:115]
    v_mfma_f32_16x16x32_bf16 v[116:119], v[252:255], v[192:195], v[116:119]
    ds_read_b128 v[192:195], v3 offset:34816
    v_mfma_f32_16x16x32_bf16 v[120:123], v[248:251], v[196:199], v[120:123]
    v_mfma_f32_16x16x32_bf16 v[124:127], v[252:255], v[196:199], v[124:127]
    ds_read_b128 v[196:199], v3 offset:35072
    v_mfma_f32_16x16x32_bf16 v[112:115], v[48:51], v[168:171], v[112:115]
    v_mfma_f32_16x16x32_bf16 v[116:119], v[52:55], v[168:171], v[116:119]
    ds_read_b128 v[168:171], v3 offset:36864
    v_mfma_f32_16x16x32_bf16 v[120:123], v[48:51], v[172:175], v[120:123]
    v_mfma_f32_16x16x32_bf16 v[124:127], v[52:55], v[172:175], v[124:127]
    ds_read_b128 v[172:175], v3 offset:37120
    v_mfma_f32_16x16x32_bf16 v[112:115], v[56:59], v[4:7], v[112:115]
    v_mfma_f32_16x16x32_bf16 v[116:119], v[60:63], v[4:7], v[116:119]
    ds_read_b128 v[4:7], v3 offset:38912
    s_waitcnt lgkmcnt(7)
    v_mfma_f32_16x16x32_bf16 v[120:123], v[56:59], v[8:11], v[120:123]
    v_mfma_f32_16x16x32_bf16 v[124:127], v[60:63], v[8:11], v[124:127]
    ds_read_b128 v[8:11], v3 offset:39168
    s_waitcnt lgkmcnt(7)
    v_mfma_f32_16x16x32_bf16 v[112:115], v[80:83], v[12:15], v[112:115]
    v_mfma_f32_16x16x32_bf16 v[116:119], v[84:87], v[12:15], v[116:119]
    s_waitcnt lgkmcnt(6)
    v_mfma_f32_16x16x32_bf16 v[120:123], v[80:83], v[164:167], v[120:123]
    v_mfma_f32_16x16x32_bf16 v[124:127], v[84:87], v[164:167], v[124:127]
    s_waitcnt lgkmcnt(5)
    v_mfma_f32_16x16x32_bf16 v[112:115], v[88:91], v[192:195], v[112:115]
    v_mfma_f32_16x16x32_bf16 v[116:119], v[92:95], v[192:195], v[116:119]
    s_waitcnt lgkmcnt(4)
    v_mfma_f32_16x16x32_bf16 v[120:123], v[88:91], v[196:199], v[120:123]
    v_mfma_f32_16x16x32_bf16 v[124:127], v[92:95], v[196:199], v[124:127]
    s_waitcnt lgkmcnt(3)
    v_mfma_f32_16x16x32_bf16 v[112:115], v[128:131], v[168:171], v[112:115]
    v_mfma_f32_16x16x32_bf16 v[116:119], v[132:135], v[168:171], v[116:119]
    s_waitcnt lgkmcnt(2)
    v_mfma_f32_16x16x32_bf16 v[120:123], v[128:131], v[172:175], v[120:123]
    v_mfma_f32_16x16x32_bf16 v[124:127], v[132:135], v[172:175], v[124:127]
    s_waitcnt lgkmcnt(1)
    v_mfma_f32_16x16x32_bf16 v[112:115], v[136:139], v[4:7], v[112:115]
    v_mfma_f32_16x16x32_bf16 v[116:119], v[140:143], v[4:7], v[116:119]
    s_waitcnt lgkmcnt(0)
    v_mfma_f32_16x16x32_bf16 v[120:123], v[136:139], v[8:11], v[120:123]
    v_mfma_f32_16x16x32_bf16 v[124:127], v[140:143], v[8:11], v[124:127]
    ds_write_b128 v161, v[112:115] offset:17408
    s_nop 0
    ds_write_b128 v161, v[116:119] offset:17472
    s_nop 1
    ds_write_b128 v161, v[120:123] offset:21760
    s_nop 1
    ds_write_b128 v161, v[124:127] offset:21824
    s_waitcnt lgkmcnt(0)
    s_barrier
    s_endpgm
LB_idle:
    s_barrier
Lend:
    s_endpgm
Lpubg_1:
    buffer_wbl2 sc1
    s_add_u32 s35, s31, 65536
    s_waitcnt vmcnt(0)
    v_mov_b32 v9, s24
    buffer_store_dword v9, v2, s[12:15], s35 offen sc1
    s_branch Lpubd_2
LA_pr0:
    s_load_dword s40, s[36:37], 2044 glc
    s_load_dword s41, s[36:37], 4092 glc
    s_load_dword s42, s[36:37], 6140 glc
    s_load_dword s43, s[36:37], 8188 glc
    s_sub_u32 s27, s27, 1
    s_cselect_b32 s27, 0, s27
    s_cselect_b32 s44, 0, 0xffff0000
    s_waitcnt lgkmcnt(0)
    s_xor_b64 s[46:47], s[40:41], s[32:33]
    s_xor_b64 s[38:39], s[42:43], s[32:33]
    s_or_b64 s[46:47], s[46:47], s[38:39]
    s_or_b32 s46, s46, s47
    s_and_b32 s46, s46, s44
    s_cbranch_scc1 LA_pr0
    s_add_u32 m0, s30, 114688
    s_nop 0
    buffer_load_dwordx4 v1, s[12:15], s29 offen offset:0 sc1 lds
    buffer_load_dwordx4 v1, s[12:15], s29 offen offset:1024 sc1 lds
    buffer_load_dwordx4 v1, s[12:15], s29 offen offset:2048 sc1 lds
    buffer_load_dwordx4 v1, s[12:15], s29 offen offset:3072 sc1 lds
    s_add_u32 m0, s30, 118784
    s_sub_u32 s27, s27, 1
    buffer_load_dwordx4 v1, s[12:15], s31 offen offset:0 sc1 lds
    buffer_load_dwordx4 v1, s[12:15], s31 offen offset:1024 sc1 lds
    buffer_load_dwordx4 v1, s[12:15], s31 offen offset:2048 sc1 lds
    buffer_load_dwordx4 v1, s[12:15], s31 offen offset:3072 sc1 lds
    s_branch LA_vf
LA_gx:
    s_mov_b32 s27, 0
    s_branch LA_gd
Lpubg_3:
    buffer_wbl2 sc1
    s_add_u32 s35, s61, 65536
    s_waitcnt vmcnt(0)
    v_mov_b32 v5, s24
    buffer_store_dword v5, v2, s[12:15], s35 offen sc1
    s_branch Lpubd_4
Lpollr_8:
    s_mov_b32 s27, 0
    s_branch Lpolld_7
Lpollg_6:
    s_add_u32 s35, s28, 65536
    buffer_load_dword v5, v4, s[12:15], s28 offen sc1
    buffer_load_dword v6, v4, s[12:15], s35 offen sc1
    s_waitcnt vmcnt(0)
    v_cmp_ne_u32 vcc, s25, v5
    v_cmp_ne_u32 s[82:83], s24, v6
    s_nop 1
    s_and_b64 vcc, vcc, s[82:83]
    s_cbranch_scc0 Lpollgd_9
    s_sub_u32 s27, s27, 1
    s_cbranch_scc0 Lpollg_6
    s_mov_b32 s27, 0
Lpollgd_9:
    buffer_inv sc1
    s_waitcnt vmcnt(0)
    s_branch Lpolld_7
Lpubg_10:
    buffer_wbl2 sc1
    s_add_u32 s35, s32, 65536
    s_waitcnt vmcnt(0)
    v_mov_b32 v5, s24
    buffer_store_dword v5, v2, s[12:15], s35 offen sc1
    s_branch Lpubd_11
Lpubg_12:
    buffer_wbl2 sc1
    s_add_u32 s35, s32, 65536
    s_waitcnt vmcnt(0)
    v_mov_b32 v5, s24
    buffer_store_dword v5, v2, s[12:15], s35 offen sc1
    s_branch Lpubd_13
Lpollr_17:
    buffer_load_dword v9, v8, s[12:15], s28 offen sc1
    s_waitcnt vmcnt(0)
    s_sub_u32 s27, s27, 1
    s_cbranch_scc0 Lpoll_14
    s_mov_b32 s27, 0
    s_branch Lpolld_16
Lpollg_15:
    s_add_u32 s35, s28, 65536
    buffer_load_dword v9, v8, s[12:15], s28 offen sc1
    buffer_load_dword v10, v8, s[12:15], s35 offen sc1
    s_waitcnt vmcnt(0)
    v_cmp_ne_u32 vcc, s25, v9
    v_cmp_ne_u32 s[82:83], s24, v10
    s_nop 1
    s_and_b64 vcc, vcc, s[82:83]
    s_cbranch_scc0 Lpollgd_18
    s_sub_u32 s27, s27, 1
    s_cbranch_scc0 Lpollg_15
    s_mov_b32 s27, 0
Lpollgd_18:
    buffer_inv sc1
    s_waitcnt vmcnt(0)
    s_branch Lpolld_16
LB_wglob:
    s_mov_b32 s26, 1
    buffer_wbl2 sc1
    s_add_u32 s29, s29, 65536
    s_add_u32 s30, s28, 65536
    v_mov_b32 v3, s24
    s_waitcnt vmcnt(0)
    buffer_store_dword v3, v2, s[12:15], s29 offen sc1
LB_wgl:
    buffer_load_dwordx2 v[6:7], v4, s[12:15], s28 offen sc1
    buffer_load_dwordx2 v[8:9], v4, s[12:15], s30 offen sc1
    s_waitcnt vmcnt(0)
    v_cmp_ne_u32 vcc, s25, v6
    v_cmp_ne_u32 s[82:83], s24, v8
    s_nop 1
    s_and_b64 s[32:33], vcc, s[82:83]
    v_cmp_ne_u32 vcc, s25, v7
    v_cmp_ne_u32 s[82:83], s24, v9
    s_nop 1
    s_and_b64 vcc, vcc, s[82:83]
    s_or_b64 vcc, vcc, s[32:33]
    s_cbranch_scc0 LB_wgd
    s_sub_u32 s27, s27, 1
    s_cbranch_scc0 LB_wgl
    s_mov_b32 s27, 0
LB_wgd:
    buffer_inv sc1
    s_waitcnt vmcnt(0)
    s_branch LB_wdone
Lpollr_22:
    s_mov_b32 s27, 0
    s_branch Lpolld_21
Lpollg_20:
    s_add_u32 s35, s28, 65536
    buffer_load_dword v10, v3, s[12:15], s28 offen sc1
    buffer_load_dword v11, v3, s[12:15], s35 offen sc1
    s_waitcnt vmcnt(0)
    v_cmp_ne_u32 vcc, s25, v10
    v_cmp_ne_u32 s[82:83], s24, v11
    s_nop 1
    s_and_b64 vcc, vcc, s[82:83]
    s_cbranch_scc0 Lpollgd_23
    s_sub_u32 s27, s27, 1
    s_cbranch_scc0 Lpollg_20
    s_mov_b32 s27, 0
Lpollgd_23:
    buffer_inv sc1
    s_waitcnt vmcnt(0)
    s_branch Lpolld_21
Lp0r:
    buffer_load_dwordx4 v[8:11], v94, s[12:15], s86 offen sc1
    s_waitcnt vmcnt(0)
    s_sub_u32 s27, s27, 1
    s_cbranch_scc0 Lp0c
    s_mov_b32 s27, 0
    s_branch Lp0d
Lfb:
    s_and_b32 s34, s6, 1
    s_lshl_b32 s34, s34, 18
    s_add_u32 s34, s34, s99
    s_mov_b32 s35, 64
    v_cndmask_b32 v86, v86, 0, s[64:65]
    v_mov_b32 v8, 0xff800000
Lfb1:
    buffer_load_dwordx4 v[64:67], v1, s[12:15], s34 offen offset:0 sc1
    buffer_load_dwordx4 v[68:71], v1, s[12:15], s34 offen offset:1024 sc1
    s_waitcnt vmcnt(0)
    v_mfma_f32_32x32x16_bf16 v[32:47], v[64:67], v[80:83], 0
    v_mfma_f32_32x32x16_bf16 v[32:47], v[68:71], v[84:87], v[32:47]
    s_add_u32 s34, s34, 4096
    s_sub_u32 s35, s35, 1
    s_cmp_lg_u32 s35, 0
    s_nop 8
    v_max3_f32 v8, v8, v32, v33
    v_max3_f32 v8, v8, v34, v35
    v_max3_f32 v8, v8, v36, v37
    v_max3_f32 v8, v8, v38, v39
    v_max3_f32 v8, v8, v40, v41
    v_max3_f32 v8, v8, v42, v43
    v_max3_f32 v8, v8, v44, v45
    v_max3_f32 v8, v8, v46, v47
    s_cbranch_scc1 Lfb1
    v_mov_b32 v9, v8
    s_nop 1
    v_permlane32_swap_b32 v9, v8
    v_max_f32 v8, v9, v8
    v_sub_f32 v8, 0, v8
    v_and_b32 v9, 0xffff0000, v8
    v_sub_f32 v8, v8, v9
    v_and_b32 v10, 0xffff0000, v8
    v_sub_f32 v8, v8, v10
    v_mov_b32 v11, 0
    v_cvt_pk_bf16_f32 v9, v9, v10
    v_cvt_pk_bf16_f32 v10, v8, v11
    v_cndmask_b32 v86, v86, v9, s[64:65]
    v_cndmask_b32 v87, v87, v10, s[64:65]
    s_sub_u32 s34, s34, 262144
    s_mov_b32 s35, 64
    v_mov_b32 v16, 0
    v_mov_b32 v17, 0
    v_mov_b32 v18, 0
    v_mov_b32 v19, 0
    v_mov_b32 v20, 0
    v_mov_b32 v21, 0
    v_mov_b32 v22, 0
    v_mov_b32 v23, 0
    v_mov_b32 v24, 0
    v_mov_b32 v25, 0
    v_mov_b32 v26, 0
    v_mov_b32 v27, 0
    v_mov_b32 v28, 0
    v_mov_b32 v29, 0
    v_mov_b32 v30, 0
    v_mov_b32 v31, 0
Lfb2:
    buffer_load_dwordx4 v[64:67], v1, s[12:15], s34 offen offset:0 sc1
    buffer_load_dwordx4 v[68:71], v1, s[12:15], s34 offen offset:1024 sc1
    buffer_load_dwordx4 v[72:75], v1, s[12:15], s34 offen offset:2048 sc1
    buffer_load_dwordx4 v[76:79], v1, s[12:15], s34 offen offset:3072 sc1
    s_waitcnt vmcnt(0)
    v_mfma_f32_32x32x16_bf16 v[32:47], v[64:67], v[80:83], 0
    v_mfma_f32_32x32x16_bf16 v[32:47], v[68:71], v[84:87], v[32:47]
    s_add_u32 s34, s34, 4096
    s_sub_u32 s35, s35, 1
    s_cmp_lg_u32 s35, 0
    s_nop 8
    v_exp_f32 v32, v32
    v_exp_f32 v33, v33
    v_exp_f32 v34, v34
    v_exp_f32 v35, v35
    v_exp_f32 v36, v36
    v_exp_f32 v37, v37
    v_exp_f32 v38, v38
    v_exp_f32 v39, v39
    v_exp_f32 v40, v40
    v_exp_f32 v41, v41
    v_exp_f32 v42, v42
    v_exp_f32 v43, v43
    v_exp_f32 v44, v44
    v_exp_f32 v45, v45
    v_exp_f32 v46, v46
    v_exp_f32 v47, v47
    v_smfmac_f32_32x32x32_bf16 v[16:31], v[72:75], v[32:39], v7
    s_nop 0
    v_smfmac_f32_32x32x32_bf16 v[16:31], v[76:79], v[40:47], v7
    s_nop 7
    s_cbranch_scc1 Lfb2
    s_nop 7
    s_branch Lfbd
Lpollr_27:
    s_mov_b32 s27, 0
    s_branch Lpolld_26
Lpollg_25:
    s_add_u32 s35, s28, 65536
    buffer_load_dword v16, v12, s[12:15], s28 offen sc1
    buffer_load_dword v17, v12, s[12:15], s35 offen sc1
    s_waitcnt vmcnt(0)
    v_cmp_ne_u32 vcc, s25, v16
    v_cmp_ne_u32 s[82:83], s24, v17
    s_nop 1
    s_and_b64 vcc, vcc, s[82:83]
    s_cbranch_scc0 Lpollgd_28
    s_sub_u32 s27, s27, 1
    s_cbranch_scc0 Lpollg_25
    s_mov_b32 s27, 0
Lpollgd_28:
    buffer_inv sc1
    s_waitcnt vmcnt(0)
    s_branch Lpolld_26
Lpollr_32:
    s_mov_b32 s27, 0
    s_branch Lpolld_31
Lpollg_30:
    s_add_u32 s35, s28, 65536
    buffer_load_dword v8, v6, s[12:15], s28 offen sc1
    buffer_load_dword v9, v6, s[12:15], s35 offen sc1
    s_waitcnt vmcnt(0)
    v_cmp_ne_u32 vcc, s25, v8
    v_cmp_ne_u32 s[82:83], s24, v9
    s_nop 1
    s_and_b64 vcc, vcc, s[82:83]
    s_cbranch_scc0 Lpollgd_33
    s_sub_u32 s27, s27, 1
    s_cbranch_scc0 Lpollg_30
    s_mov_b32 s27, 0
Lpollgd_33:
    buffer_inv sc1
    s_waitcnt vmcnt(0)
    s_branch Lpolld_31
Lcode_end:
    s_endpgm
.section .rodata,"a"
.p2align 6
.amdhsa_kernel sequential_preLN__mha_block__dense_activation_squared_relu__prompt_kernel
  .amdhsa_next_free_vgpr 256
  .amdhsa_next_free_sgpr 102
  .amdhsa_accum_offset 256
  .amdhsa_group_segment_fixed_size 0
  .amdhsa_kernarg_size 88
  .amdhsa_user_sgpr_count 2
  .amdhsa_user_sgpr_kernarg_segment_ptr 1
  .amdhsa_system_sgpr_workgroup_id_x 1
.end_amdhsa_kernel
```
